```python
import torch

def _softmax(x, axis=-1):
    return torch.softmax(x, dim=axis)
def _gelu(x):
    return torch.nn.functional.gelu(x, approximate="tanh")
def _silu(x):
    return torch.nn.functional.silu(x)
def _sigmoid(x):
    return torch.sigmoid(x)
def _layernorm(x, axis=-1, eps=1e-5):
    m = x.mean(dim=axis, keepdim=True)
    v = x.var(dim=axis, keepdim=True, unbiased=False)
    return (x - m) / torch.sqrt(v + eps)
def _scatter_add(tgt, idx, src, axis=0):
    return tgt.clone().index_add_(axis, idx, src)
def _segment_sum(src, seg, n):
    out = torch.zeros((n,) + src.shape[1:], dtype=src.dtype)
    return out.index_add_(0, seg, src)
def _pad(x, pw):
    flat = tuple(v for pair in reversed(pw) for v in pair)
    return torch.nn.functional.pad(x, flat)

kernel_name = 'parallel_sum__sliding_block__glu_gated_bilinear__prompt'

def setup_inputs():

    _w = (lambda a: (lambda t: t.to(torch.bfloat16) if t.is_floating_point() else t)(torch.as_tensor(a)))
    def _A_setup():
        B, S, D = 1, 2048, 640
        return {
            "x": _w((lambda *s: torch.randn(*s, dtype=torch.bfloat16) * 0.05)(B, S, D)),
            "wqkv": _w((lambda *s: torch.randn(*s, dtype=torch.bfloat16) * 0.05)(D, 3 * D)),
            "wo": _w((lambda *s: torch.randn(*s, dtype=torch.bfloat16) * 0.05)(D, D)),
        }
    _A_in = _A_setup()

    def _B_setup():
        B, S, D, F = 1, 2048, 640, 1536
        return {
            "x": _w((lambda *s: torch.randn(*s, dtype=torch.bfloat16) * 0.05)(B, S, D)),
            "w_gate": _w((lambda *s: torch.randn(*s, dtype=torch.bfloat16) * 0.8)(D, F) * (D ** -0.5)),
            "w_up": _w((lambda *s: torch.randn(*s, dtype=torch.bfloat16) * 0.8)(D, F) * (D ** -0.5)),
            "w_down": _w((lambda *s: torch.randn(*s, dtype=torch.bfloat16) * 0.8)(F, D) * (F ** -0.5)),
        }
    _B_in = _B_setup()

    return {
        "A_x": _A_in["x"],
        "A_wqkv": _A_in["wqkv"],
        "A_wo": _A_in["wo"],
        "B_x": _B_in["x"],
        "B_w_gate": _B_in["w_gate"],
        "B_w_up": _B_in["w_up"],
        "B_w_down": _B_in["w_down"],
    }

def reference(A_x, A_wqkv, A_wo, B_x, B_w_gate, B_w_up, B_w_down):
    def _A_ref(x, wqkv, wo):
        B, S, D = x.shape
        H = 32; Dh = D // H; W = 256
        qkv = (lambda x, *d: x.permute(*d))((x @ wqkv).reshape(B, S, 3, H, Dh), 2, 0, 3, 1, 4)
        q, k, v = qkv[0], qkv[1], qkv[2]
        scores = torch.einsum("bhqd,bhkd->bhqk", q, k) * (Dh ** -0.5)
        idx = torch.arange(S)
        mask = (idx[:, None] - idx[None, :] >= 0) & (idx[:, None] - idx[None, :] < W)
        scores = torch.where(mask[None, None], scores, -1e9)
        p = _softmax(scores, axis=-1)
        o = torch.einsum("bhqk,bhkd->bhqd", p, v)
        return (lambda x, *d: x.permute(*d))(o, 0, 2, 1, 3).reshape(B, S, D) @ wo

    def _B_ref(x, w_gate, w_up, w_down):
        g = torch.einsum("bsd,df->bsf", x, w_gate)
        u = torch.einsum("bsd,df->bsf", x, w_up)
        h = g * u
        return torch.einsum("bsf,fd->bsd", h, w_down)

    x = A_x
    xn = _layernorm(x, axis=-1)
    return x + _A_ref(xn, A_wqkv, A_wo) + _B_ref(xn, B_w_gate, B_w_up, B_w_down)
```

```asm
; @launch grid=(256,1,1) block=(512,1,1) lds=163840
.amdgcn_target "amdgcn-amd-amdhsa--gfx950"
.text
.globl parallel_sum__sliding_block__glu_gated_bilinear__prompt_kernel
.p2align 8
.type parallel_sum__sliding_block__glu_gated_bilinear__prompt_kernel,@function
parallel_sum__sliding_block__glu_gated_bilinear__prompt_kernel:
  s_cmp_ge_u32 s2, 256
  s_cbranch_scc1 END
  s_load_dwordx16 s[48:63], s[0:1], 0
  s_load_dwordx4 s[64:67], s[0:1], 64
  v_lshrrev_b32 v1, 6, v0
  v_and_b32 v0, 63, v0
  v_readfirstlane_b32 s34, v1
  s_and_b32 s38, s2, 7
  s_lshr_b32 s39, s2, 3
  s_and_b32 s40, s39, 7
  s_lshr_b32 s41, s39, 3
  s_and_b32 s32, s38, 1
  s_lshl_b32 s32, s32, 3
  s_add_u32 s32, s32, s40
  s_lshr_b32 s33, s38, 1
  s_lshl_b32 s33, s33, 2
  s_add_u32 s33, s33, s41
  s_lshl_b32 s44, s38, 2
  s_and_b32 s45, s39, 3
  s_add_u32 s44, s44, s45
  s_lshr_b32 s45, s39, 2
  s_and_b32 s35, s34, 3
  s_lshr_b32 s36, s34, 2
  s_mov_b32 s37, 0x3f803f80
  s_lshl_b32 s46, s34, 11
  s_mul_i32 s47, s34, 3072
  s_waitcnt lgkmcnt(0)
  s_mov_b32 s4, s48
  s_mov_b32 s5, s49
  s_mov_b32 s6, 2621440
  s_mov_b32 s7, 0x20000
  s_mov_b32 s8, s50
  s_mov_b32 s9, s51
  s_mov_b32 s10, 2457600
  s_mov_b32 s11, 0x20000
  s_mov_b32 s20, s66
  s_mov_b32 s21, s67
  s_mov_b32 s22, 33554432
  s_mov_b32 s23, 0x20000
  s_mov_b32 s24, s62
  s_mov_b32 s25, s63
  s_mov_b32 s26, 2621440
  s_mov_b32 s27, 0x20000
  s_cmp_eq_u32 s36, 0
  s_cselect_b32 s12, s56, s58
  s_cselect_b32 s13, s57, s59
  s_mov_b32 s14, 1966080
  s_mov_b32 s15, 0x20000
  s_mov_b32 s38, 21495808
  s_load_dword s3, s[66:67], s38
  s_mul_i32 s93, s32, 43
  s_lshr_b32 s93, s93, 7
  s_min_u32 s93, s93, 4
  s_mul_i32 s38, s93, 3
  s_sub_u32 s94, s32, s38
  s_lshl_b32 s92, s93, 1
  v_lshrrev_b32 v19, 3, v0
  v_lshrrev_b32 v22, 4, v0
  v_and_b32 v23, 7, v0
  s_lshl_b32 s38, s32, 7
  s_lshl_b32 s39, s34, 4
  s_add_u32 s38, s38, s39
  v_add_u32 v19, s38, v19
  v_mul_u32_u24 v19, 1280, v19
  v_xor_b32 v23, v23, v22
  v_lshl_add_u32 v1, v23, 4, v19
  v_xor_b32 v23, 4, v23
  v_add_u32 v19, 9216, v19
  v_lshl_add_u32 v2, v23, 4, v19
  s_lshl_b32 s39, s34, 3
  v_add_u32 v19, s39, v22
  v_mul_u32_u24 v3, 3840, v19
  v_bfe_u32 v23, v0, 2, 2
  v_xor_b32 v23, v23, v22
  v_lshl_add_u32 v3, v23, 6, v3
  v_and_b32 v23, 3, v0
  v_lshl_add_u32 v3, v23, 4, v3
  s_lshl_b32 s38, s33, 8
  v_add_u32 v3, s38, v3
  s_mov_b32 s16, s60
  s_mov_b32 s17, s61
  s_mov_b32 s18, 1966080
  s_mov_b32 s19, 0x20000
  s_cmp_eq_u32 s33, 15
  s_cbranch_scc1 LZ_3
  s_add_u32 m0, s46, 131072
  s_lshl_b32 s78, s92, 7
  buffer_load_dwordx4 v1, s[4:7], s78 offen lds
  buffer_load_dwordx4 v2, s[4:7], s78 offen offset:1024 lds
  s_add_u32 m0, s46, 147456
  s_mul_i32 s78, s92, 245760
  buffer_load_dwordx4 v3, s[8:11], s78 offen lds
  s_add_u32 s92, s92, 1
  s_cmp_eq_u32 s92, 10
  s_cselect_b32 s92, 0, s92
  s_add_u32 s78, s78, 14336
  buffer_load_dwordx4 v3, s[8:11], s78 offen offset:1024 lds
  s_lshl_b32 s38, s32, 4
  s_add_u32 s38, s38, s33
  s_lshl_b32 s79, s38, 8
  s_add_u32 s79, s79, 21364736
  s_lshl_b32 s38, s38, 3
  s_add_u32 s69, s38, s34
  s_mul_i32 s38, s69, 1280
  v_lshlrev_b32 v253, 4, v0
  v_lshlrev_b32 v255, 2, v0
  buffer_load_dwordx4 v[248:251], v253, s[4:7], s38 offen
  buffer_load_dword v252, v255, s[4:7], s38 offen offset:1024
  s_lshl_b32 s69, s69, 4
  s_add_u32 s69, s69, 20971520
  s_mul_i32 s93, s93, 160
  s_mul_i32 s38, s33, 10
  s_add_u32 s93, s93, s38
  s_add_u32 s93, s93, s94
  s_lshl_b32 s93, s93, 8
  s_add_u32 s93, s93, 21037056
  s_cmp_eq_u32 s34, 0
  s_cselect_b32 s79, s79, 117440512
  s_cselect_b32 s93, s93, 117440512
  s_add_u32 m0, s46, 32768
  s_lshl_b32 s78, s92, 7
  buffer_load_dwordx4 v1, s[4:7], s78 offen lds
  buffer_load_dwordx4 v2, s[4:7], s78 offen offset:1024 lds
  s_add_u32 m0, s46, 49152
  s_mul_i32 s78, s92, 245760
  buffer_load_dwordx4 v3, s[8:11], s78 offen lds
  s_add_u32 s92, s92, 1
  s_cmp_eq_u32 s92, 10
  s_cselect_b32 s92, 0, s92
  s_add_u32 s78, s78, 14336
  buffer_load_dwordx4 v3, s[8:11], s78 offen offset:1024 lds
  v_add_u32 v19, 0, v0
  v_mul_u32_u24 v22, 171, v19
  v_lshrrev_b32 v22, 11, v22
  v_mul_u32_u24 v23, 12, v22
  v_sub_u32 v19, v19, v23
  s_lshl_b32 s38, s36, 1
  v_xor_b32 v19, s38, v19
  v_mul_u32_u24 v22, 3072, v22
  v_lshl_add_u32 v4, v19, 4, v22
  s_mul_i32 s38, s35, 49152
  s_mul_i32 s39, s33, 192
  s_add_u32 s38, s38, s39
  s_sub_u32 s38, s38, 0
  v_add_u32 v4, s38, v4
  v_add_u32 v19, 64, v0
  v_mul_u32_u24 v22, 171, v19
  v_lshrrev_b32 v22, 11, v22
  v_mul_u32_u24 v23, 12, v22
  v_sub_u32 v19, v19, v23
  s_lshl_b32 s38, s36, 1
  v_xor_b32 v19, s38, v19
  v_mul_u32_u24 v22, 3072, v22
  v_lshl_add_u32 v5, v19, 4, v22
  s_mul_i32 s38, s35, 49152
  s_mul_i32 s39, s33, 192
  s_add_u32 s38, s38, s39
  s_sub_u32 s38, s38, 1024
  v_add_u32 v5, s38, v5
  v_add_u32 v19, 128, v0
  v_mul_u32_u24 v22, 171, v19
  v_lshrrev_b32 v22, 11, v22
  v_mul_u32_u24 v23, 12, v22
  v_sub_u32 v19, v19, v23
  s_lshl_b32 s38, s36, 1
  v_xor_b32 v19, s38, v19
  v_mul_u32_u24 v22, 3072, v22
  v_lshl_add_u32 v6, v19, 4, v22
  s_mul_i32 s38, s35, 49152
  s_mul_i32 s39, s33, 192
  s_add_u32 s38, s38, s39
  s_sub_u32 s38, s38, 2048
  v_add_u32 v6, s38, v6
  v_and_b32 v19, 31, v0
  v_lshrrev_b32 v22, 5, v0
  v_bfe_u32 v23, v0, 1, 3
  v_xor_b32 v23, v23, v22
  v_lshlrev_b32 v23, 4, v23
  v_lshl_add_u32 v7, v19, 7, v23
  s_lshl_b32 s38, s35, 12
  v_add_u32 v7, s38, v7
  v_bfe_u32 v19, v0, 2, 2
  v_lshlrev_b32 v9, 11, v22
  v_lshl_add_u32 v9, v19, 8, v9
  v_and_b32 v23, 1, v0
  v_lshl_add_u32 v9, v23, 5, v9
  v_and_b32 v23, 16, v0
  v_add_u32 v9, v23, v9
  v_and_b32 v23, 2, v0
  v_lshl_add_u32 v9, v23, 2, v9
  s_lshl_b32 s38, s36, 1
  v_xor_b32 v23, s38, v19
  v_lshl_add_u32 v9, v23, 6, v9
  v_xor_b32 v10, 64, v9
  v_lshl_add_u32 v19, v22, 3, v19
  v_mul_u32_u24 v19, 192, v19
  v_bfe_u32 v22, v0, 4, 1
  v_mul_u32_u24 v23, 12288, v22
  v_add_u32 v19, v19, v23
  v_and_b32 v23, 1, v0
  v_lshl_add_u32 v19, v23, 4, v19
  v_and_b32 v23, 2, v0
  v_lshl_add_u32 v19, v23, 2, v19
  v_add_u32 v19, 0x10000, v19
  s_mul_i32 s38, s36, 3
  s_add_u32 s39, s38, 0
  v_xor_b32 v23, s39, v22
  v_lshl_add_u32 v11, v23, 5, v19
  s_add_u32 s39, s38, 1
  v_xor_b32 v23, s39, v22
  v_lshl_add_u32 v12, v23, 5, v19
  s_add_u32 s39, s38, 2
  v_xor_b32 v23, s39, v22
  v_lshl_add_u32 v13, v23, 5, v19
  v_add_u32 v9, 0x18000, v9
  v_add_u32 v10, 0x18000, v10
  s_and_b32 s38, s94, 1
  s_lshl_b32 s38, s38, 6
  v_xor_b32 v253, s38, v9
  s_lshl_b32 s38, s35, 12
  v_add_u32 v253, s38, v253
  v_mov_b32 v232, s37
  v_mov_b32 v233, s37
  v_mov_b32 v234, s37
  v_mov_b32 v235, s37
  s_waitcnt vmcnt(6) lgkmcnt(0)
  s_barrier
  s_add_u32 s3, s3, 0x9e3779b8
  v_xor_b32 v8, 131072, v7
  ds_read_b128 v[96:99], v8
  ds_read_b64_tr_b16 v[24:25], v9 offset:49152
  ds_read_b64_tr_b16 v[26:27], v9 offset:50176
  ds_read_b64_tr_b16 v[28:29], v10 offset:49152
  ds_read_b64_tr_b16 v[30:31], v10 offset:50176
  ds_read_b64_tr_b16 v[224:225], v253 offset:49152
  ds_read_b64_tr_b16 v[226:227], v253 offset:50176
  v_xor_b32 v8, 131104, v7
  ds_read_b128 v[100:103], v8
  ds_read_b64_tr_b16 v[32:33], v9 offset:53248
  ds_read_b64_tr_b16 v[34:35], v9 offset:54272
  ds_read_b64_tr_b16 v[36:37], v10 offset:53248
  ds_read_b64_tr_b16 v[38:39], v10 offset:54272
  v_xor_b32 v8, 131136, v7
  ds_read_b128 v[104:107], v8
  ds_read_b64_tr_b16 v[40:41], v9 offset:57344
  ds_read_b64_tr_b16 v[42:43], v9 offset:58368
  ds_read_b64_tr_b16 v[44:45], v10 offset:57344
  ds_read_b64_tr_b16 v[46:47], v10 offset:58368
  s_add_u32 m0, s46, 65536
  s_lshl_b32 s78, s92, 7
  buffer_load_dwordx4 v1, s[4:7], s78 offen lds
  buffer_load_dwordx4 v2, s[4:7], s78 offen offset:1024 lds
  s_add_u32 m0, s46, 81920
  s_mul_i32 s78, s92, 245760
  buffer_load_dwordx4 v3, s[8:11], s78 offen lds
  s_add_u32 s92, s92, 1
  s_cmp_eq_u32 s92, 10
  s_cselect_b32 s92, 0, s92
  s_add_u32 s78, s78, 14336
  buffer_load_dwordx4 v3, s[8:11], s78 offen offset:1024 lds
  s_cmp_ge_u32 s33, 10
  s_cbranch_scc1 LV_1
  s_waitcnt lgkmcnt(14)
  v_mfma_f32_32x32x16_bf16 v[48:63], v[24:27], v[96:99], 0
  v_xor_b32 v8, 131168, v7
  ds_read_b128 v[108:111], v8
  ds_read_b64_tr_b16 v[24:25], v9 offset:61440
  ds_read_b64_tr_b16 v[26:27], v9 offset:62464
  s_add_u32 m0, s46, 98304
  s_lshl_b32 s78, s92, 7
  buffer_load_dwordx4 v1, s[4:7], s78 offen lds
  s_waitcnt lgkmcnt(15)
  v_mfma_f32_32x32x16_bf16 v[64:79], v[28:31], v[96:99], 0
  ds_read_b64_tr_b16 v[28:29], v10 offset:61440
  ds_read_b64_tr_b16 v[30:31], v10 offset:62464
  buffer_load_dwordx4 v2, s[4:7], s78 offen offset:1024 lds
  s_waitcnt lgkmcnt(15)
  v_mfma_f32_32x32x16_bf16 v[80:95], v[232:235], v[224:227], 0
  s_waitcnt lgkmcnt(12)
  v_mfma_f32_32x32x16_bf16 v[48:63], v[32:35], v[100:103], v[48:63]
  s_waitcnt vmcnt(6)
  s_barrier
  v_xor_b32 v9, 0x10000, v9
  v_xor_b32 v8, 32768, v7
  ds_read_b128 v[112:115], v8
  ds_read_b64_tr_b16 v[32:33], v9 offset:16384
  ds_read_b64_tr_b16 v[34:35], v9 offset:17408
  s_add_u32 m0, s46, 114688
  s_mul_i32 s78, s92, 245760
  buffer_load_dwordx4 v3, s[8:11], s78 offen lds
  s_add_u32 s92, s92, 1
  s_cmp_eq_u32 s92, 10
  s_cselect_b32 s92, 0, s92
  v_mov_b32 v20, 0
  v_mov_b32 v21, 0
  v_dot2c_f32_bf16 v20, s37, v248
  v_xor_b32 v253, 0x10000, v253
  ds_read_b64_tr_b16 v[228:229], v253 offset:16384
  ds_read_b64_tr_b16 v[230:231], v253 offset:17408
  s_waitcnt lgkmcnt(15)
  v_mfma_f32_32x32x16_bf16 v[64:79], v[36:39], v[100:103], v[64:79]
  v_xor_b32 v10, 0x10000, v10
  ds_read_b64_tr_b16 v[36:37], v10 offset:16384
  ds_read_b64_tr_b16 v[38:39], v10 offset:17408
  s_add_u32 s78, s78, 14336
  buffer_load_dwordx4 v3, s[8:11], s78 offen offset:1024 lds
  v_dot2c_f32_bf16 v21, v248, v248
  v_dot2c_f32_bf16 v20, s37, v249
  v_dot2c_f32_bf16 v21, v249, v249
  s_waitcnt lgkmcnt(14)
  v_mfma_f32_32x32x16_bf16 v[48:63], v[40:43], v[104:107], v[48:63]
  v_xor_b32 v8, 32800, v7
  ds_read_b128 v[116:119], v8
  ds_read_b64_tr_b16 v[40:41], v9 offset:20480
  ds_read_b64_tr_b16 v[42:43], v9 offset:21504
  s_add_u32 m0, s46, 131072
  s_lshl_b32 s78, s92, 7
  buffer_load_dwordx4 v1, s[4:7], s78 offen lds
  v_dot2c_f32_bf16 v20, s37, v250
  v_dot2c_f32_bf16 v21, v250, v250
  v_dot2c_f32_bf16 v20, s37, v251
  s_waitcnt lgkmcnt(15)
  v_mfma_f32_32x32x16_bf16 v[64:79], v[44:47], v[104:107], v[64:79]
  ds_read_b64_tr_b16 v[44:45], v10 offset:20480
  ds_read_b64_tr_b16 v[46:47], v10 offset:21504
  buffer_load_dwordx4 v2, s[4:7], s78 offen offset:1024 lds
  v_dot2c_f32_bf16 v21, v251, v251
  v_dot2c_f32_bf16 v20, s37, v252
  v_dot2c_f32_bf16 v21, v252, v252
  s_waitcnt lgkmcnt(7)
  v_mfma_f32_32x32x16_bf16 v[80:95], v[232:235], v[228:231], v[80:95]
  v_mfma_f32_32x32x16_bf16 v[48:63], v[24:27], v[108:111], v[48:63]
  v_xor_b32 v8, 32832, v7
  ds_read_b128 v[120:123], v8
  ds_read_b64_tr_b16 v[24:25], v9 offset:24576
  ds_read_b64_tr_b16 v[26:27], v9 offset:25600
  s_add_u32 m0, s46, 147456
  s_mul_i32 s78, s92, 245760
  buffer_load_dwordx4 v3, s[8:11], s78 offen lds
  s_add_u32 s92, s92, 1
  s_cmp_eq_u32 s92, 10
  s_cselect_b32 s92, 0, s92
  v_permlane32_swap_b32 v20, v21
  v_add_f32 v20, v20, v21
  v_mov_b32 v21, v20
  v_and_b32 v253, 3, v0
  v_bfe_u32 v224, v0, 2, 1
  v_lshl_add_u32 v253, v224, 4, v253
  v_bfe_u32 v224, v0, 3, 2
  v_lshl_add_u32 v253, v224, 2, v253
  v_mfma_f32_32x32x16_bf16 v[64:79], v[28:31], v[108:111], v[64:79]
  ds_read_b64_tr_b16 v[28:29], v10 offset:24576
  ds_read_b64_tr_b16 v[30:31], v10 offset:25600
  s_add_u32 s78, s78, 14336
  buffer_load_dwordx4 v3, s[8:11], s78 offen offset:1024 lds
  v_permlane16_swap_b32 v20, v21
  v_add_f32 v20, v20, v21
  v_mfma_f32_32x32x16_bf16 v[48:63], v[32:35], v[112:115], v[48:63]
  v_xor_b32 v8, 32864, v7
  ds_read_b128 v[124:127], v8
  ds_read_b64_tr_b16 v[32:33], v9 offset:28672
  ds_read_b64_tr_b16 v[34:35], v9 offset:29696
  v_add_f32_dpp v20, v20, v20 row_ror:8 row_mask:0xf bank_mask:0xf
  s_lshl_b32 s38, s35, 8
  s_lshl_b32 s39, s36, 7
  s_add_u32 s38, s38, s39
  v_lshl_add_u32 v253, v253, 2, s38
  ds_write_b32 v253, v80 offset:4096
  v_lshlrev_b32 v224, 2, v0
  s_waitcnt lgkmcnt(14)
  v_mfma_f32_32x32x16_bf16 v[64:79], v[36:39], v[112:115], v[64:79]
  ds_read_b64_tr_b16 v[36:37], v10 offset:28672
  ds_read_b64_tr_b16 v[38:39], v10 offset:29696
  v_add_f32_dpp v20, v20, v20 row_ror:4 row_mask:0xf bank_mask:0xf
  s_mul_i32 s39, s32, 15
  s_add_u32 s39, s39, s33
  s_mul_i32 s38, s39, 205
  s_lshr_b32 s38, s38, 10
  s_mul_i32 s40, s38, 5
  s_sub_u32 s39, s39, s40
  s_lshl_b32 s40, s38, 3
  s_add_u32 s40, s40, s34
  s_mul_i32 s40, s40, 5120
  s_lshl_b32 s41, s39, 8
  s_add_u32 s40, s40, s41
  v_lshrrev_b32 v254, 4, v0
  v_lshlrev_b32 v254, 10, v254
  v_lshl_add_u32 v254, v0, 4, v254
  s_lshr_b32 s41, s46, 1
  s_add_u32 m0, s41, 16384
  s_lshl_b32 s39, s39, 3
  s_add_u32 s39, s39, s34
  buffer_load_dwordx4 v254, s[16:19], s40 offen lds
  s_mul_i32 s40, s39, 205
  s_lshr_b32 s40, s40, 10
  s_mul_i32 s40, s40, 335
  s_add_u32 s40, s40, s39
  s_mul_i32 s38, s38, 5
  s_add_u32 s40, s40, s38
  s_lshl_b32 s40, s40, 10
  s_add_u32 s68, s40, 16777216
  s_waitcnt lgkmcnt(13)
  v_mfma_f32_32x32x16_bf16 v[48:63], v[40:43], v[116:119], v[48:63]
  s_waitcnt vmcnt(9)
  s_waitcnt lgkmcnt(2)
  s_barrier
  v_xor_b32 v8, 65536, v7
  ds_read_b128 v[128:131], v8
  ds_read_b64_tr_b16 v[40:41], v9 offset:49152
  ds_read_b64_tr_b16 v[42:43], v9 offset:50176
  s_add_u32 m0, s46, 32768
  s_lshl_b32 s78, s92, 7
  buffer_load_dwordx4 v1, s[4:7], s78 offen lds
  v_add_f32_dpp v20, v20, v20 row_ror:2 row_mask:0xf bank_mask:0xf
  ds_read2st64_b32 v[232:233], v224 offset0:16 offset1:17
  ds_read2st64_b32 v[234:235], v224 offset0:18 offset1:19
  v_lshrrev_b32 v253, 5, v0
  v_lshlrev_b32 v253, 8, v253
  v_lshl_add_u32 v253, v0, 3, v253
  v_mfma_f32_32x32x16_bf16 v[64:79], v[44:47], v[116:119], v[64:79]
  ds_read_b64_tr_b16 v[44:45], v10 offset:49152
  ds_read_b64_tr_b16 v[46:47], v10 offset:50176
  v_add_f32_dpp v20, v20, v20 row_ror:1 row_mask:0xf bank_mask:0xf
  v_mul_f32 v20, 0x3acccccd, v20
  v_mov_b32 v21, v20
  v_mfma_f32_32x32x16_bf16 v[48:63], v[24:27], v[120:123], v[48:63]
  v_xor_b32 v8, 65568, v7
  ds_read_b128 v[132:135], v8
  ds_read_b64_tr_b16 v[24:25], v9 offset:53248
  ds_read_b64_tr_b16 v[26:27], v9 offset:54272
  buffer_load_dwordx4 v2, s[4:7], s78 offen offset:1024 lds
  v_permlane32_swap_b32 v20, v21
  v_fma_f32 v21, -v20, v20, v21
  v_max_f32 v21, 0, v21
  v_mfma_f32_32x32x16_bf16 v[64:79], v[28:31], v[120:123], v[64:79]
  ds_read_b64_tr_b16 v[28:29], v10 offset:53248
  ds_read_b64_tr_b16 v[30:31], v10 offset:54272
  v_cvt_pk_bf16_f32 v20, v20, v21
  v_and_b32 v21, 0xffff0000, v20
  v_add_f32 v21, 0x3727c5ac, v21
  s_cmp_lt_u32 s94, 2
  s_cselect_b32 s38, s93, 117440512
  v_add_u32 v253, s38, v253
  s_waitcnt lgkmcnt(7)
  v_add_f32 v232, v232, v233
  v_add_f32 v234, v234, v235
  v_mov_b32 v233, s3
  v_add_f32 v232, v232, v234
  buffer_store_dwordx2 v[232:233], v253, s[20:23], 0 offen offset:0 sc1
  v_mfma_f32_32x32x16_bf16 v[48:63], v[32:35], v[124:127], v[48:63]
  v_xor_b32 v8, 65600, v7
  ds_read_b128 v[136:139], v8
  ds_read_b64_tr_b16 v[32:33], v9 offset:57344
  ds_read_b64_tr_b16 v[34:35], v9 offset:58368
  s_add_u32 m0, s46, 49152
  s_mul_i32 s78, s92, 245760
  buffer_load_dwordx4 v3, s[8:11], s78 offen lds
  s_add_u32 s92, s92, 1
  s_cmp_eq_u32 s92, 10
  s_cselect_b32 s92, 0, s92
  v_cvt_pk_bf16_f32 v21, v21, v21
  v_lshlrev_b32 v21, 16, v21
  v_sqrt_f32 v21, v21
  v_mfma_f32_32x32x16_bf16 v[64:79], v[36:39], v[124:127], v[64:79]
  ds_read_b64_tr_b16 v[36:37], v10 offset:57344
  ds_read_b64_tr_b16 v[38:39], v10 offset:58368
  v_lshlrev_b32 v20, 16, v20
  v_cvt_pk_bf16_f32 v21, v21, v21
  v_lshlrev_b32 v21, 16, v21
  v_mfma_f32_32x32x16_bf16 v[48:63], v[40:43], v[128:131], v[48:63]
  v_xor_b32 v8, 65632, v7
  ds_read_b128 v[140:143], v8
  ds_read_b64_tr_b16 v[40:41], v9 offset:61440
  ds_read_b64_tr_b16 v[42:43], v9 offset:62464
  s_add_u32 s78, s78, 14336
  buffer_load_dwordx4 v3, s[8:11], s78 offen offset:1024 lds
  v_rcp_f32 v21, v21
  v_sub_f32 v20, 0, v20
  v_mov_b32 v22, s3
  s_waitcnt lgkmcnt(13)
  v_mfma_f32_32x32x16_bf16 v[64:79], v[44:47], v[128:131], v[64:79]
  ds_read_b64_tr_b16 v[44:45], v10 offset:61440
  ds_read_b64_tr_b16 v[46:47], v10 offset:62464
  v_mov_b32 v23, s3
  s_waitcnt lgkmcnt(12)
  v_mfma_f32_32x32x16_bf16 v[48:63], v[24:27], v[132:135], v[48:63]
  s_waitcnt vmcnt(10)
  s_barrier
  v_xor_b32 v9, 0x10000, v9
  v_xor_b32 v8, 98304, v7
  ds_read_b128 v[144:147], v8
  ds_read_b64_tr_b16 v[24:25], v9 offset:16384
  ds_read_b64_tr_b16 v[26:27], v9 offset:17408
  s_add_u32 m0, s46, 65536
  s_lshl_b32 s78, s92, 7
  buffer_load_dwordx4 v1, s[4:7], s78 offen lds
  s_mov_b64 exec, 1
  buffer_store_dwordx4 v[20:23], off, s[20:23], s69 sc1
  s_mov_b64 exec, -1
  s_waitcnt lgkmcnt(13)
  v_mfma_f32_32x32x16_bf16 v[64:79], v[28:31], v[132:135], v[64:79]
  v_xor_b32 v10, 0x10000, v10
  ds_read_b64_tr_b16 v[28:29], v10 offset:16384
  ds_read_b64_tr_b16 v[30:31], v10 offset:17408
  s_waitcnt lgkmcnt(12)
  v_mfma_f32_32x32x16_bf16 v[48:63], v[32:35], v[136:139], v[48:63]
  v_xor_b32 v8, 98336, v7
  ds_read_b128 v[148:151], v8
  ds_read_b64_tr_b16 v[32:33], v9 offset:20480
  ds_read_b64_tr_b16 v[34:35], v9 offset:21504
  buffer_load_dwordx4 v2, s[4:7], s78 offen offset:1024 lds
  s_waitcnt lgkmcnt(13)
  v_mfma_f32_32x32x16_bf16 v[64:79], v[36:39], v[136:139], v[64:79]
  ds_read_b64_tr_b16 v[36:37], v10 offset:20480
  ds_read_b64_tr_b16 v[38:39], v10 offset:21504
  s_waitcnt lgkmcnt(12)
  v_mfma_f32_32x32x16_bf16 v[48:63], v[40:43], v[140:143], v[48:63]
  v_xor_b32 v8, 98368, v7
  ds_read_b128 v[152:155], v8
  ds_read_b64_tr_b16 v[40:41], v9 offset:24576
  ds_read_b64_tr_b16 v[42:43], v9 offset:25600
  s_add_u32 m0, s46, 81920
  s_mul_i32 s78, s92, 245760
  buffer_load_dwordx4 v3, s[8:11], s78 offen lds
  s_add_u32 s92, s92, 1
  s_cmp_eq_u32 s92, 10
  s_cselect_b32 s92, 0, s92
  s_waitcnt lgkmcnt(13)
  v_mfma_f32_32x32x16_bf16 v[64:79], v[44:47], v[140:143], v[64:79]
  ds_read_b64_tr_b16 v[44:45], v10 offset:24576
  ds_read_b64_tr_b16 v[46:47], v10 offset:25600
  s_waitcnt lgkmcnt(12)
  v_mfma_f32_32x32x16_bf16 v[48:63], v[24:27], v[144:147], v[48:63]
  v_xor_b32 v8, 98400, v7
  ds_read_b128 v[156:159], v8
  ds_read_b64_tr_b16 v[24:25], v9 offset:28672
  ds_read_b64_tr_b16 v[26:27], v9 offset:29696
  s_add_u32 s78, s78, 14336
  buffer_load_dwordx4 v3, s[8:11], s78 offen offset:1024 lds
  s_waitcnt lgkmcnt(13)
  v_mfma_f32_32x32x16_bf16 v[64:79], v[28:31], v[144:147], v[64:79]
  ds_read_b64_tr_b16 v[28:29], v10 offset:28672
  ds_read_b64_tr_b16 v[30:31], v10 offset:29696
  s_waitcnt lgkmcnt(12)
  v_mfma_f32_32x32x16_bf16 v[48:63], v[32:35], v[148:151], v[48:63]
  s_waitcnt vmcnt(11)
  s_barrier
  v_xor_b32 v8, 131072, v7
  ds_read_b128 v[160:163], v8
  ds_read_b64_tr_b16 v[32:33], v9 offset:49152
  ds_read_b64_tr_b16 v[34:35], v9 offset:50176
  s_add_u32 m0, s46, 98304
  s_lshl_b32 s78, s92, 7
  buffer_load_dwordx4 v1, s[4:7], s78 offen lds
  s_waitcnt lgkmcnt(13)
  v_mfma_f32_32x32x16_bf16 v[64:79], v[36:39], v[148:151], v[64:79]
  ds_read_b64_tr_b16 v[36:37], v10 offset:49152
  ds_read_b64_tr_b16 v[38:39], v10 offset:50176
  s_waitcnt lgkmcnt(12)
  v_mfma_f32_32x32x16_bf16 v[48:63], v[40:43], v[152:155], v[48:63]
  v_xor_b32 v8, 131104, v7
  ds_read_b128 v[164:167], v8
  ds_read_b64_tr_b16 v[40:41], v9 offset:53248
  ds_read_b64_tr_b16 v[42:43], v9 offset:54272
  buffer_load_dwordx4 v2, s[4:7], s78 offen offset:1024 lds
  s_waitcnt lgkmcnt(13)
  v_mfma_f32_32x32x16_bf16 v[64:79], v[44:47], v[152:155], v[64:79]
  ds_read_b64_tr_b16 v[44:45], v10 offset:53248
  ds_read_b64_tr_b16 v[46:47], v10 offset:54272
  s_waitcnt lgkmcnt(12)
  v_mfma_f32_32x32x16_bf16 v[48:63], v[24:27], v[156:159], v[48:63]
  v_xor_b32 v8, 131136, v7
  ds_read_b128 v[168:171], v8
  ds_read_b64_tr_b16 v[24:25], v9 offset:57344
  ds_read_b64_tr_b16 v[26:27], v9 offset:58368
  s_add_u32 m0, s46, 114688
  s_mul_i32 s78, s92, 245760
  buffer_load_dwordx4 v3, s[8:11], s78 offen lds
  s_add_u32 s92, s92, 1
  s_cmp_eq_u32 s92, 10
  s_cselect_b32 s92, 0, s92
  s_waitcnt lgkmcnt(13)
  v_mfma_f32_32x32x16_bf16 v[64:79], v[28:31], v[156:159], v[64:79]
  ds_read_b64_tr_b16 v[28:29], v10 offset:57344
  ds_read_b64_tr_b16 v[30:31], v10 offset:58368
  s_waitcnt lgkmcnt(12)
  v_mfma_f32_32x32x16_bf16 v[48:63], v[32:35], v[160:163], v[48:63]
  v_xor_b32 v8, 131168, v7
  ds_read_b128 v[172:175], v8
  ds_read_b64_tr_b16 v[32:33], v9 offset:61440
  ds_read_b64_tr_b16 v[34:35], v9 offset:62464
  s_add_u32 s78, s78, 14336
  buffer_load_dwordx4 v3, s[8:11], s78 offen offset:1024 lds
  s_waitcnt lgkmcnt(13)
  v_mfma_f32_32x32x16_bf16 v[64:79], v[36:39], v[160:163], v[64:79]
  ds_read_b64_tr_b16 v[36:37], v10 offset:61440
  ds_read_b64_tr_b16 v[38:39], v10 offset:62464
  s_waitcnt lgkmcnt(12)
  v_mfma_f32_32x32x16_bf16 v[48:63], v[40:43], v[164:167], v[48:63]
  s_waitcnt vmcnt(9)
  s_barrier
  v_xor_b32 v9, 0x10000, v9
  v_xor_b32 v8, 32768, v7
  ds_read_b128 v[176:179], v8
  ds_read_b64_tr_b16 v[40:41], v9 offset:16384
  ds_read_b64_tr_b16 v[42:43], v9 offset:17408
  s_add_u32 m0, s46, 131072
  s_lshl_b32 s78, s92, 7
  buffer_load_dwordx4 v1, s[4:7], s78 offen lds
  s_waitcnt lgkmcnt(13)
  v_mfma_f32_32x32x16_bf16 v[64:79], v[44:47], v[164:167], v[64:79]
  v_xor_b32 v10, 0x10000, v10
  ds_read_b64_tr_b16 v[44:45], v10 offset:16384
  ds_read_b64_tr_b16 v[46:47], v10 offset:17408
  s_waitcnt lgkmcnt(12)
  v_mfma_f32_32x32x16_bf16 v[48:63], v[24:27], v[168:171], v[48:63]
  v_xor_b32 v8, 32800, v7
  ds_read_b128 v[180:183], v8
  ds_read_b64_tr_b16 v[24:25], v9 offset:20480
  ds_read_b64_tr_b16 v[26:27], v9 offset:21504
  buffer_load_dwordx4 v2, s[4:7], s78 offen offset:1024 lds
  s_waitcnt lgkmcnt(13)
  v_mfma_f32_32x32x16_bf16 v[64:79], v[28:31], v[168:171], v[64:79]
  ds_read_b64_tr_b16 v[28:29], v10 offset:20480
  ds_read_b64_tr_b16 v[30:31], v10 offset:21504
  s_waitcnt lgkmcnt(12)
  v_mfma_f32_32x32x16_bf16 v[48:63], v[32:35], v[172:175], v[48:63]
  v_xor_b32 v8, 32832, v7
  ds_read_b128 v[184:187], v8
  ds_read_b64_tr_b16 v[32:33], v9 offset:24576
  ds_read_b64_tr_b16 v[34:35], v9 offset:25600
  s_add_u32 m0, s46, 147456
  s_mul_i32 s78, s92, 245760
  buffer_load_dwordx4 v3, s[8:11], s78 offen lds
  s_add_u32 s92, s92, 1
  s_cmp_eq_u32 s92, 10
  s_cselect_b32 s92, 0, s92
  s_waitcnt lgkmcnt(13)
  v_mfma_f32_32x32x16_bf16 v[64:79], v[36:39], v[172:175], v[64:79]
  ds_read_b64_tr_b16 v[36:37], v10 offset:24576
  ds_read_b64_tr_b16 v[38:39], v10 offset:25600
  s_waitcnt lgkmcnt(12)
  v_mfma_f32_32x32x16_bf16 v[48:63], v[40:43], v[176:179], v[48:63]
  v_xor_b32 v8, 32864, v7
  ds_read_b128 v[188:191], v8
  ds_read_b64_tr_b16 v[40:41], v9 offset:28672
  ds_read_b64_tr_b16 v[42:43], v9 offset:29696
  s_add_u32 s78, s78, 14336
  buffer_load_dwordx4 v3, s[8:11], s78 offen offset:1024 lds
  s_waitcnt lgkmcnt(13)
  v_mfma_f32_32x32x16_bf16 v[64:79], v[44:47], v[176:179], v[64:79]
  ds_read_b64_tr_b16 v[44:45], v10 offset:28672
  ds_read_b64_tr_b16 v[46:47], v10 offset:29696
  s_waitcnt lgkmcnt(12)
  v_mfma_f32_32x32x16_bf16 v[48:63], v[24:27], v[180:183], v[48:63]
  s_waitcnt vmcnt(8)
  s_barrier
  v_xor_b32 v8, 65536, v7
  ds_read_b128 v[192:195], v8
  ds_read_b64_tr_b16 v[24:25], v9 offset:49152
  ds_read_b64_tr_b16 v[26:27], v9 offset:50176
  s_add_u32 m0, s46, 32768
  s_lshl_b32 s78, s92, 7
  buffer_load_dwordx4 v1, s[4:7], s78 offen lds
  s_min_u32 s38, s34, 1
  s_lshl_b32 s38, s38, 8
  v_lshl_add_u32 v16, v0, 2, s38
  s_mul_i32 s38, s33, 2560
  v_lshl_add_u32 v17, v16, 1, s38
  s_lshl_b32 s38, s32, 2
  s_add_u32 s38, s38, s35
  s_lshl_b32 s38, s38, 9
  s_add_u32 s38, s38, 20971520
  v_and_b32 v19, 31, v0
  v_lshl_add_u32 v18, v19, 4, s38
  s_waitcnt lgkmcnt(13)
  v_mfma_f32_32x32x16_bf16 v[64:79], v[28:31], v[180:183], v[64:79]
  ds_read_b64_tr_b16 v[28:29], v10 offset:49152
  ds_read_b64_tr_b16 v[30:31], v10 offset:50176
  s_mov_b32 s38, 21037056
  buffer_load_dwordx2 v[80:81], v17, s[20:23], s38 offen sc1
  s_waitcnt lgkmcnt(12)
  v_mfma_f32_32x32x16_bf16 v[48:63], v[32:35], v[184:187], v[48:63]
  v_xor_b32 v8, 65568, v7
  ds_read_b128 v[196:199], v8
  ds_read_b64_tr_b16 v[32:33], v9 offset:53248
  ds_read_b64_tr_b16 v[34:35], v9 offset:54272
  buffer_load_dwordx4 v2, s[4:7], s78 offen offset:1024 lds
  s_waitcnt lgkmcnt(13)
  v_mfma_f32_32x32x16_bf16 v[64:79], v[36:39], v[184:187], v[64:79]
  ds_read_b64_tr_b16 v[36:37], v10 offset:53248
  ds_read_b64_tr_b16 v[38:39], v10 offset:54272
  s_mov_b32 s38, 21078016
  buffer_load_dwordx2 v[82:83], v17, s[20:23], s38 offen sc1
  s_waitcnt lgkmcnt(12)
  v_mfma_f32_32x32x16_bf16 v[48:63], v[40:43], v[188:191], v[48:63]
  v_xor_b32 v8, 65600, v7
  ds_read_b128 v[200:203], v8
  ds_read_b64_tr_b16 v[40:41], v9 offset:57344
  ds_read_b64_tr_b16 v[42:43], v9 offset:58368
  s_add_u32 m0, s46, 49152
  s_mul_i32 s78, s92, 245760
  buffer_load_dwordx4 v3, s[8:11], s78 offen lds
  s_add_u32 s92, s92, 1
  s_cmp_eq_u32 s92, 10
  s_cselect_b32 s92, 0, s92
  s_waitcnt lgkmcnt(13)
  v_mfma_f32_32x32x16_bf16 v[64:79], v[44:47], v[188:191], v[64:79]
  ds_read_b64_tr_b16 v[44:45], v10 offset:57344
  ds_read_b64_tr_b16 v[46:47], v10 offset:58368
  s_mov_b32 s38, 21118976
  buffer_load_dwordx2 v[84:85], v17, s[20:23], s38 offen sc1
  s_waitcnt lgkmcnt(12)
  v_mfma_f32_32x32x16_bf16 v[48:63], v[24:27], v[192:195], v[48:63]
  v_xor_b32 v8, 65632, v7
  ds_read_b128 v[204:207], v8
  ds_read_b64_tr_b16 v[24:25], v9 offset:61440
  ds_read_b64_tr_b16 v[26:27], v9 offset:62464
  s_add_u32 s78, s78, 14336
  buffer_load_dwordx4 v3, s[8:11], s78 offen offset:1024 lds
  s_waitcnt lgkmcnt(13)
  v_mfma_f32_32x32x16_bf16 v[64:79], v[28:31], v[192:195], v[64:79]
  ds_read_b64_tr_b16 v[28:29], v10 offset:61440
  ds_read_b64_tr_b16 v[30:31], v10 offset:62464
  s_mov_b32 s38, 21159936
  buffer_load_dwordx2 v[86:87], v17, s[20:23], s38 offen sc1
  s_waitcnt lgkmcnt(12)
  v_mfma_f32_32x32x16_bf16 v[48:63], v[32:35], v[196:199], v[48:63]
  s_waitcnt vmcnt(12)
  s_barrier
  v_xor_b32 v9, 0x10000, v9
  v_xor_b32 v8, 98304, v7
  ds_read_b128 v[208:211], v8
  ds_read_b64_tr_b16 v[32:33], v9 offset:16384
  ds_read_b64_tr_b16 v[34:35], v9 offset:17408
  s_add_u32 m0, s47, 65536
  s_mul_i32 s78, s92, 196608
  buffer_load_dwordx4 v4, s[12:15], s78 offen lds
  s_waitcnt lgkmcnt(13)
  v_mfma_f32_32x32x16_bf16 v[64:79], v[36:39], v[196:199], v[64:79]
  v_xor_b32 v10, 0x10000, v10
  ds_read_b64_tr_b16 v[36:37], v10 offset:16384
  ds_read_b64_tr_b16 v[38:39], v10 offset:17408
  s_mov_b32 s38, 21200896
  buffer_load_dwordx2 v[88:89], v17, s[20:23], s38 offen sc1
  s_waitcnt lgkmcnt(12)
  v_mfma_f32_32x32x16_bf16 v[48:63], v[40:43], v[200:203], v[48:63]
  v_xor_b32 v8, 98336, v7
  ds_read_b128 v[212:215], v8
  ds_read_b64_tr_b16 v[40:41], v9 offset:20480
  ds_read_b64_tr_b16 v[42:43], v9 offset:21504
  buffer_load_dwordx4 v5, s[12:15], s78 offen offset:1024 lds
  s_waitcnt lgkmcnt(13)
  v_mfma_f32_32x32x16_bf16 v[64:79], v[44:47], v[200:203], v[64:79]
  ds_read_b64_tr_b16 v[44:45], v10 offset:20480
  ds_read_b64_tr_b16 v[46:47], v10 offset:21504
  buffer_load_dwordx4 v[20:23], v18, s[20:23], 0 offen sc1
  s_waitcnt lgkmcnt(12)
  v_mfma_f32_32x32x16_bf16 v[48:63], v[24:27], v[204:207], v[48:63]
  v_xor_b32 v8, 98368, v7
  ds_read_b128 v[216:219], v8
  ds_read_b64_tr_b16 v[24:25], v9 offset:24576
  ds_read_b64_tr_b16 v[26:27], v9 offset:25600
  buffer_load_dwordx4 v6, s[12:15], s78 offen offset:2048 lds
  s_add_u32 s92, s92, 1
  s_cmp_eq_u32 s92, 10
  s_cselect_b32 s92, 0, s92
  s_waitcnt lgkmcnt(13)
  v_mfma_f32_32x32x16_bf16 v[64:79], v[28:31], v[204:207], v[64:79]
  ds_read_b64_tr_b16 v[28:29], v10 offset:24576
  ds_read_b64_tr_b16 v[30:31], v10 offset:25600
  s_waitcnt lgkmcnt(12)
  v_mfma_f32_32x32x16_bf16 v[48:63], v[32:35], v[208:211], v[48:63]
  v_xor_b32 v8, 98400, v7
  ds_read_b128 v[220:223], v8
  ds_read_b64_tr_b16 v[32:33], v9 offset:28672
  ds_read_b64_tr_b16 v[34:35], v9 offset:29696
  s_waitcnt lgkmcnt(13)
  v_mfma_f32_32x32x16_bf16 v[64:79], v[36:39], v[208:211], v[64:79]
  ds_read_b64_tr_b16 v[36:37], v10 offset:28672
  ds_read_b64_tr_b16 v[38:39], v10 offset:29696
  s_waitcnt lgkmcnt(12)
  v_mfma_f32_32x32x16_bf16 v[48:63], v[40:43], v[212:215], v[48:63]
  s_waitcnt vmcnt(13)
  s_barrier
  v_xor_b32 v8, 131072, v7
  ds_read_b128 v[224:227], v8
  ds_read_b64_tr_b16 v[40:41], v9 offset:49152
  ds_read_b64_tr_b16 v[42:43], v9 offset:50176
  s_add_u32 m0, s47, 90112
  s_mul_i32 s78, s92, 196608
  buffer_load_dwordx4 v4, s[12:15], s78 offen lds
  s_waitcnt lgkmcnt(13)
  v_mfma_f32_32x32x16_bf16 v[64:79], v[44:47], v[212:215], v[64:79]
  ds_read_b64_tr_b16 v[44:45], v10 offset:49152
  ds_read_b64_tr_b16 v[46:47], v10 offset:50176
  s_waitcnt lgkmcnt(12)
  v_mfma_f32_32x32x16_bf16 v[48:63], v[24:27], v[216:219], v[48:63]
  v_xor_b32 v8, 131104, v7
  ds_read_b128 v[228:231], v8
  ds_read_b64_tr_b16 v[24:25], v9 offset:53248
  ds_read_b64_tr_b16 v[26:27], v9 offset:54272
  buffer_load_dwordx4 v5, s[12:15], s78 offen offset:1024 lds
  s_waitcnt lgkmcnt(13)
  v_mfma_f32_32x32x16_bf16 v[64:79], v[28:31], v[216:219], v[64:79]
  ds_read_b64_tr_b16 v[28:29], v10 offset:53248
  ds_read_b64_tr_b16 v[30:31], v10 offset:54272
  s_waitcnt lgkmcnt(12)
  v_mfma_f32_32x32x16_bf16 v[48:63], v[32:35], v[220:223], v[48:63]
  v_xor_b32 v8, 131136, v7
  ds_read_b128 v[232:235], v8
  ds_read_b64_tr_b16 v[32:33], v9 offset:57344
  ds_read_b64_tr_b16 v[34:35], v9 offset:58368
  buffer_load_dwordx4 v6, s[12:15], s78 offen offset:2048 lds
  s_add_u32 s92, s92, 1
  s_cmp_eq_u32 s92, 10
  s_cselect_b32 s92, 0, s92
  s_waitcnt lgkmcnt(13)
  v_mfma_f32_32x32x16_bf16 v[64:79], v[36:39], v[220:223], v[64:79]
  ds_read_b64_tr_b16 v[36:37], v10 offset:57344
  ds_read_b64_tr_b16 v[38:39], v10 offset:58368
  s_waitcnt lgkmcnt(12)
  v_mfma_f32_32x32x16_bf16 v[48:63], v[40:43], v[224:227], v[48:63]
  v_xor_b32 v8, 131168, v7
  ds_read_b128 v[236:239], v8
  ds_read_b64_tr_b16 v[40:41], v9 offset:61440
  ds_read_b64_tr_b16 v[42:43], v9 offset:62464
  s_waitcnt lgkmcnt(13)
  v_mfma_f32_32x32x16_bf16 v[64:79], v[44:47], v[224:227], v[64:79]
  ds_read_b64_tr_b16 v[44:45], v10 offset:61440
  ds_read_b64_tr_b16 v[46:47], v10 offset:62464
  s_waitcnt lgkmcnt(12)
  v_mfma_f32_32x32x16_bf16 v[48:63], v[24:27], v[228:231], v[48:63]
  s_waitcnt vmcnt(9)
  s_barrier
  v_xor_b32 v9, 0x10000, v9
  v_xor_b32 v8, 32768, v7
  ds_read_b128 v[240:243], v8
  ds_read_b64_tr_b16 v[24:25], v9 offset:16384
  ds_read_b64_tr_b16 v[26:27], v9 offset:17408
  s_add_u32 m0, s47, 114688
  s_mul_i32 s78, s92, 196608
  buffer_load_dwordx4 v4, s[12:15], s78 offen lds
  s_waitcnt lgkmcnt(13)
  v_mfma_f32_32x32x16_bf16 v[64:79], v[28:31], v[228:231], v[64:79]
  v_xor_b32 v10, 0x10000, v10
  ds_read_b64_tr_b16 v[28:29], v10 offset:16384
  ds_read_b64_tr_b16 v[30:31], v10 offset:17408
  s_waitcnt lgkmcnt(12)
  v_mfma_f32_32x32x16_bf16 v[48:63], v[32:35], v[232:235], v[48:63]
  v_xor_b32 v8, 32800, v7
  ds_read_b128 v[244:247], v8
  ds_read_b64_tr_b16 v[32:33], v9 offset:20480
  ds_read_b64_tr_b16 v[34:35], v9 offset:21504
  buffer_load_dwordx4 v5, s[12:15], s78 offen offset:1024 lds
  s_waitcnt lgkmcnt(13)
  v_mfma_f32_32x32x16_bf16 v[64:79], v[36:39], v[232:235], v[64:79]
  ds_read_b64_tr_b16 v[36:37], v10 offset:20480
  ds_read_b64_tr_b16 v[38:39], v10 offset:21504
  s_waitcnt lgkmcnt(12)
  v_mfma_f32_32x32x16_bf16 v[48:63], v[40:43], v[236:239], v[48:63]
  v_xor_b32 v8, 32832, v7
  ds_read_b128 v[248:251], v8
  ds_read_b64_tr_b16 v[40:41], v9 offset:24576
  ds_read_b64_tr_b16 v[42:43], v9 offset:25600
  buffer_load_dwordx4 v6, s[12:15], s78 offen offset:2048 lds
  s_add_u32 s92, s92, 1
  s_cmp_eq_u32 s92, 10
  s_cselect_b32 s92, 0, s92
  s_waitcnt vmcnt(7)
  v_xor_b32 v81, s3, v81
  v_xor_b32 v83, s3, v83
  v_xor_b32 v85, s3, v85
  v_xor_b32 v87, s3, v87
  v_xor_b32 v89, s3, v89
  v_xor_b32 v22, s3, v22
  v_or_b32 v81, v81, v22
  v_or3_b32 v81, v81, v83, v85
  v_or3_b32 v81, v81, v87, v89
  v_cmp_ne_u32 vcc, 0, v81
  s_cbranch_vccnz SP_4
RT_5:
  v_add_f32 v80, v80, v82
  v_add_f32 v84, v84, v86
  v_add_f32 v80, v80, v88
  v_add_f32 v80, v80, v84
  ds_write_b32 v16, v80 offset:0
  s_waitcnt lgkmcnt(14)
  v_mfma_f32_32x32x16_bf16 v[64:79], v[44:47], v[236:239], v[64:79]
  ds_read_b64_tr_b16 v[44:45], v10 offset:24576
  ds_read_b64_tr_b16 v[46:47], v10 offset:25600
  s_waitcnt lgkmcnt(13)
  v_mfma_f32_32x32x16_bf16 v[48:63], v[24:27], v[240:243], v[48:63]
  v_xor_b32 v8, 32864, v7
  ds_read_b128 v[252:255], v8
  ds_read_b64_tr_b16 v[24:25], v9 offset:28672
  ds_read_b64_tr_b16 v[26:27], v9 offset:29696
  s_waitcnt lgkmcnt(14)
  v_mfma_f32_32x32x16_bf16 v[64:79], v[28:31], v[240:243], v[64:79]
  ds_read_b64_tr_b16 v[28:29], v10 offset:28672
  ds_read_b64_tr_b16 v[30:31], v10 offset:29696
  s_waitcnt lgkmcnt(13)
  v_mfma_f32_32x32x16_bf16 v[48:63], v[32:35], v[244:247], v[48:63]
  s_waitcnt vmcnt(6)
  s_waitcnt lgkmcnt(7)
  s_barrier
  ds_read_b64_tr_b16 v[32:33], v11 offset:0
  ds_read_b64_tr_b16 v[34:35], v11 offset:768
  s_add_u32 m0, s47, 139264
  s_mul_i32 s78, s92, 196608
  buffer_load_dwordx4 v4, s[12:15], s78 offen lds
  v_mfma_f32_32x32x16_bf16 v[64:79], v[36:39], v[244:247], v[64:79]
  ds_read_b64_tr_b16 v[36:37], v12 offset:0
  ds_read_b64_tr_b16 v[38:39], v12 offset:768
  v_mfma_f32_32x32x16_bf16 v[48:63], v[40:43], v[248:251], v[48:63]
  ds_read_b64_tr_b16 v[40:41], v13 offset:0
  ds_read_b64_tr_b16 v[42:43], v13 offset:768
  s_waitcnt lgkmcnt(11)
  v_mfma_f32_32x32x16_bf16 v[64:79], v[44:47], v[248:251], v[64:79]
  ds_read_b64_tr_b16 v[44:45], v11 offset:3072
  ds_read_b64_tr_b16 v[46:47], v11 offset:3840
  buffer_load_dwordx4 v5, s[12:15], s78 offen offset:1024 lds
  s_waitcnt lgkmcnt(10)
  v_mfma_f32_32x32x16_bf16 v[48:63], v[24:27], v[252:255], v[48:63]
  ds_read_b64_tr_b16 v[24:25], v12 offset:3072
  ds_read_b64_tr_b16 v[26:27], v12 offset:3840
  s_waitcnt lgkmcnt(10)
  v_mfma_f32_32x32x16_bf16 v[64:79], v[28:31], v[252:255], v[64:79]
  ds_read_b64_tr_b16 v[28:29], v13 offset:3072
  ds_read_b64_tr_b16 v[30:31], v13 offset:3840
  s_lshl_b32 s39, s35, 7
  s_lshl_b32 s38, s36, 8
  v_lshrrev_b32 v7, 5, v0
  v_lshl_add_u32 v22, v7, 6, s38
  ds_read_b128 v[80:83], v22 offset:0
  ds_read_b128 v[84:87], v22 offset:16
  ds_read_b128 v[88:91], v22 offset:32
  ds_read_b128 v[92:95], v22 offset:48
  s_cmp_lt_u32 s33, 5
  s_cselect_b32 s40, 0x3ea52b5c, 1.0
  s_cselect_b32 s41, 0, 5
  s_cselect_b32 s42, 1, 2
  s_cselect_b32 s43, 0, 2621440
  v_mul_f32 v14, s40, v21
  s_sub_u32 s41, s33, s41
  s_lshl_b32 s41, s41, 4
  s_lshl_b32 s40, s36, 3
  s_add_u32 s41, s41, s40
  s_lshl_b32 s40, s32, 2
  s_add_u32 s40, s40, s35
  s_mul_i32 s40, s40, 2560
  s_mul_i32 s40, s40, s42
  s_add_u32 s43, s43, s40
  s_mul_i32 s42, s42, 163840
  s_sub_u32 s42, s42, 2560
  v_lshrrev_b32 v19, 5, v0
  v_lshl_add_u32 v19, v19, 1, s41
  v_and_b32 v23, 31, v0
  v_lshlrev_b32 v23, 4, v23
  s_waitcnt lgkmcnt(0)
  v_pk_fma_f32 v[48:49], v[80:81], v[20:21], v[48:49] op_sel_hi:[1,0,1]
  v_pk_fma_f32 v[50:51], v[82:83], v[20:21], v[50:51] op_sel_hi:[1,0,1]
  v_pk_fma_f32 v[52:53], v[84:85], v[20:21], v[52:53] op_sel_hi:[1,0,1]
  v_pk_fma_f32 v[54:55], v[86:87], v[20:21], v[54:55] op_sel_hi:[1,0,1]
  v_pk_fma_f32 v[56:57], v[88:89], v[20:21], v[56:57] op_sel_hi:[1,0,1]
  v_pk_fma_f32 v[58:59], v[90:91], v[20:21], v[58:59] op_sel_hi:[1,0,1]
  v_pk_fma_f32 v[60:61], v[92:93], v[20:21], v[60:61] op_sel_hi:[1,0,1]
  v_pk_fma_f32 v[62:63], v[94:95], v[20:21], v[62:63] op_sel_hi:[1,0,1]
  ds_read_b128 v[80:83], v22 offset:128
  ds_read_b128 v[84:87], v22 offset:144
  ds_read_b128 v[88:91], v22 offset:160
  ds_read_b128 v[92:95], v22 offset:176
  v_pk_mul_f32 v[48:49], v[48:49], v[14:15] op_sel_hi:[1,0]
  v_pk_mul_f32 v[50:51], v[50:51], v[14:15] op_sel_hi:[1,0]
  v_pk_mul_f32 v[52:53], v[52:53], v[14:15] op_sel_hi:[1,0]
  v_pk_mul_f32 v[54:55], v[54:55], v[14:15] op_sel_hi:[1,0]
  v_pk_mul_f32 v[56:57], v[56:57], v[14:15] op_sel_hi:[1,0]
  v_pk_mul_f32 v[58:59], v[58:59], v[14:15] op_sel_hi:[1,0]
  v_pk_mul_f32 v[60:61], v[60:61], v[14:15] op_sel_hi:[1,0]
  v_pk_mul_f32 v[62:63], v[62:63], v[14:15] op_sel_hi:[1,0]
  v_cvt_pk_bf16_f32 v48, v48, v49
  v_cvt_pk_bf16_f32 v49, v50, v51
  v_cvt_pk_bf16_f32 v50, v52, v53
  v_cvt_pk_bf16_f32 v51, v54, v55
  v_cvt_pk_bf16_f32 v52, v56, v57
  v_cvt_pk_bf16_f32 v53, v58, v59
  v_cvt_pk_bf16_f32 v54, v60, v61
  v_cvt_pk_bf16_f32 v55, v62, v63
  v_add_u32 v7, 0, v19
  v_mul_u32_u24 v9, 205, v7
  v_lshrrev_b32 v9, 10, v9
  v_lshl_add_u32 v7, v7, 9, v23
  v_mad_u32_u24 v7, v9, s42, v7
  buffer_store_dwordx4 v[48:51], v7, s[20:23], s43 offen sc1
  v_add_u32 v8, 1, v19
  v_mul_u32_u24 v9, 205, v8
  v_lshrrev_b32 v9, 10, v9
  v_lshl_add_u32 v8, v8, 9, v23
  v_mad_u32_u24 v8, v9, s42, v8
  buffer_store_dwordx4 v[52:55], v8, s[20:23], s43 offen sc1
  s_waitcnt lgkmcnt(0)
  v_pk_fma_f32 v[64:65], v[80:81], v[20:21], v[64:65] op_sel_hi:[1,0,1]
  v_pk_fma_f32 v[66:67], v[82:83], v[20:21], v[66:67] op_sel_hi:[1,0,1]
  v_pk_fma_f32 v[68:69], v[84:85], v[20:21], v[68:69] op_sel_hi:[1,0,1]
  v_pk_fma_f32 v[70:71], v[86:87], v[20:21], v[70:71] op_sel_hi:[1,0,1]
  v_pk_fma_f32 v[72:73], v[88:89], v[20:21], v[72:73] op_sel_hi:[1,0,1]
  v_pk_fma_f32 v[74:75], v[90:91], v[20:21], v[74:75] op_sel_hi:[1,0,1]
  v_pk_fma_f32 v[76:77], v[92:93], v[20:21], v[76:77] op_sel_hi:[1,0,1]
  v_pk_fma_f32 v[78:79], v[94:95], v[20:21], v[78:79] op_sel_hi:[1,0,1]
  v_pk_mul_f32 v[64:65], v[64:65], v[14:15] op_sel_hi:[1,0]
  v_pk_mul_f32 v[66:67], v[66:67], v[14:15] op_sel_hi:[1,0]
  v_pk_mul_f32 v[68:69], v[68:69], v[14:15] op_sel_hi:[1,0]
  v_pk_mul_f32 v[70:71], v[70:71], v[14:15] op_sel_hi:[1,0]
  v_pk_mul_f32 v[72:73], v[72:73], v[14:15] op_sel_hi:[1,0]
  v_pk_mul_f32 v[74:75], v[74:75], v[14:15] op_sel_hi:[1,0]
  v_pk_mul_f32 v[76:77], v[76:77], v[14:15] op_sel_hi:[1,0]
  v_pk_mul_f32 v[78:79], v[78:79], v[14:15] op_sel_hi:[1,0]
  v_cvt_pk_bf16_f32 v64, v64, v65
  v_cvt_pk_bf16_f32 v65, v66, v67
  v_cvt_pk_bf16_f32 v66, v68, v69
  v_cvt_pk_bf16_f32 v67, v70, v71
  v_cvt_pk_bf16_f32 v68, v72, v73
  v_cvt_pk_bf16_f32 v69, v74, v75
  v_cvt_pk_bf16_f32 v70, v76, v77
  v_cvt_pk_bf16_f32 v71, v78, v79
  v_add_u32 v7, 4, v19
  v_mul_u32_u24 v9, 205, v7
  v_lshrrev_b32 v9, 10, v9
  v_lshl_add_u32 v7, v7, 9, v23
  v_mad_u32_u24 v7, v9, s42, v7
  buffer_store_dwordx4 v[64:67], v7, s[20:23], s43 offen sc1
  v_add_u32 v8, 5, v19
  v_mul_u32_u24 v9, 205, v8
  v_lshrrev_b32 v9, 10, v9
  v_lshl_add_u32 v8, v8, 9, v23
  v_mad_u32_u24 v8, v9, s42, v8
  buffer_store_dwordx4 v[68:71], v8, s[20:23], s43 offen sc1
  s_nop 1
  s_branch LJ_2
LZ_3:
  s_mov_b32 s28, s52
  s_mov_b32 s29, s53
  s_mov_b32 s30, 819200
  s_mov_b32 s31, 0x20000
  s_mov_b32 s68, 117440512
  s_mul_i32 s38, s34, 10240
  v_lshrrev_b32 v3, 4, v0
  v_mul_u32_u24 v3, 1024, v3
  v_lshl_add_u32 v3, v0, 4, v3
  v_add_u32 v3, s38, v3
  s_lshl_b32 s38, s32, 4
  s_add_u32 s38, s38, s33
  s_lshl_b32 s79, s38, 8
  s_add_u32 s79, s79, 21364736
  s_lshl_b32 s38, s38, 3
  s_add_u32 s69, s38, s34
  s_mul_i32 s38, s69, 1280
  v_lshlrev_b32 v253, 4, v0
  v_lshlrev_b32 v255, 2, v0
  buffer_load_dwordx4 v[248:251], v253, s[4:7], s38 offen
  buffer_load_dword v252, v255, s[4:7], s38 offen offset:1024
  s_lshl_b32 s69, s69, 4
  s_add_u32 s69, s69, 20971520
  s_mul_i32 s93, s93, 160
  s_mul_i32 s38, s33, 10
  s_add_u32 s93, s93, s38
  s_add_u32 s93, s93, s94
  s_lshl_b32 s93, s93, 8
  s_add_u32 s93, s93, 21037056
  s_cmp_eq_u32 s34, 0
  s_cselect_b32 s79, s79, 117440512
  s_cselect_b32 s93, s93, 117440512
  s_add_u32 m0, s46, 131072
  s_lshl_b32 s78, s92, 7
  buffer_load_dwordx4 v1, s[4:7], s78 offen lds
  buffer_load_dwordx4 v2, s[4:7], s78 offen offset:1024 lds
  s_add_u32 s92, s92, 1
  s_cmp_eq_u32 s92, 10
  s_cselect_b32 s92, 0, s92
  s_add_u32 s39, s32, 0
  s_mul_i32 s38, s39, 205
  s_lshr_b32 s38, s38, 10
  s_mul_i32 s40, s38, 5
  s_sub_u32 s39, s39, s40
  s_mul_i32 s40, s38, 81920
  s_lshl_b32 s39, s39, 8
  s_add_u32 s40, s40, s39
  s_add_u32 m0, s46, 147456
  s_add_u32 s41, s40, 4096
  buffer_load_dwordx4 v3, s[28:31], s40 offen lds
  buffer_load_dwordx4 v3, s[28:31], s41 offen offset:1024 lds
  s_add_u32 m0, s46, 32768
  s_lshl_b32 s78, s92, 7
  buffer_load_dwordx4 v1, s[4:7], s78 offen lds
  buffer_load_dwordx4 v2, s[4:7], s78 offen offset:1024 lds
  s_add_u32 s92, s92, 1
  s_cmp_eq_u32 s92, 10
  s_cselect_b32 s92, 0, s92
  s_add_u32 s39, s32, 16
  s_mul_i32 s38, s39, 205
  s_lshr_b32 s38, s38, 10
  s_mul_i32 s40, s38, 5
  s_sub_u32 s39, s39, s40
  s_mul_i32 s40, s38, 81920
  s_lshl_b32 s39, s39, 8
  s_add_u32 s40, s40, s39
  s_add_u32 m0, s46, 49152
  s_add_u32 s41, s40, 4096
  buffer_load_dwordx4 v3, s[28:31], s40 offen lds
  buffer_load_dwordx4 v3, s[28:31], s41 offen offset:1024 lds
  s_add_u32 m0, s46, 65536
  s_lshl_b32 s78, s92, 7
  buffer_load_dwordx4 v1, s[4:7], s78 offen lds
  buffer_load_dwordx4 v2, s[4:7], s78 offen offset:1024 lds
  s_add_u32 s92, s92, 1
  s_cmp_eq_u32 s92, 10
  s_cselect_b32 s92, 0, s92
  s_add_u32 s39, s32, 32
  s_mul_i32 s38, s39, 205
  s_lshr_b32 s38, s38, 10
  s_mul_i32 s40, s38, 5
  s_sub_u32 s39, s39, s40
  s_mul_i32 s40, s38, 81920
  s_lshl_b32 s39, s39, 8
  s_add_u32 s40, s40, s39
  s_add_u32 m0, s46, 81920
  s_add_u32 s41, s40, 4096
  buffer_load_dwordx4 v3, s[28:31], s40 offen lds
  buffer_load_dwordx4 v3, s[28:31], s41 offen offset:1024 lds
  s_add_u32 m0, s46, 98304
  s_lshl_b32 s78, s92, 7
  buffer_load_dwordx4 v1, s[4:7], s78 offen lds
  buffer_load_dwordx4 v2, s[4:7], s78 offen offset:1024 lds
  s_add_u32 s92, s92, 1
  s_cmp_eq_u32 s92, 10
  s_cselect_b32 s92, 0, s92
  s_add_u32 s39, s32, 48
  s_min_u32 s39, s39, 49
  s_mul_i32 s38, s39, 205
  s_lshr_b32 s38, s38, 10
  s_mul_i32 s40, s38, 5
  s_sub_u32 s39, s39, s40
  s_mul_i32 s40, s38, 81920
  s_lshl_b32 s39, s39, 8
  s_add_u32 s40, s40, s39
  s_add_u32 m0, s46, 114688
  s_add_u32 s41, s40, 4096
  buffer_load_dwordx4 v3, s[28:31], s40 offen lds
  buffer_load_dwordx4 v3, s[28:31], s41 offen offset:1024 lds
  v_add_u32 v19, 0, v0
  v_mul_u32_u24 v22, 171, v19
  v_lshrrev_b32 v22, 11, v22
  v_mul_u32_u24 v23, 12, v22
  v_sub_u32 v19, v19, v23
  s_lshl_b32 s38, s36, 1
  v_xor_b32 v19, s38, v19
  v_mul_u32_u24 v22, 3072, v22
  v_lshl_add_u32 v4, v19, 4, v22
  s_mul_i32 s38, s35, 49152
  s_mul_i32 s39, s33, 192
  s_add_u32 s38, s38, s39
  s_sub_u32 s38, s38, 0
  v_add_u32 v4, s38, v4
  v_add_u32 v19, 64, v0
  v_mul_u32_u24 v22, 171, v19
  v_lshrrev_b32 v22, 11, v22
  v_mul_u32_u24 v23, 12, v22
  v_sub_u32 v19, v19, v23
  s_lshl_b32 s38, s36, 1
  v_xor_b32 v19, s38, v19
  v_mul_u32_u24 v22, 3072, v22
  v_lshl_add_u32 v5, v19, 4, v22
  s_mul_i32 s38, s35, 49152
  s_mul_i32 s39, s33, 192
  s_add_u32 s38, s38, s39
  s_sub_u32 s38, s38, 1024
  v_add_u32 v5, s38, v5
  v_add_u32 v19, 128, v0
  v_mul_u32_u24 v22, 171, v19
  v_lshrrev_b32 v22, 11, v22
  v_mul_u32_u24 v23, 12, v22
  v_sub_u32 v19, v19, v23
  s_lshl_b32 s38, s36, 1
  v_xor_b32 v19, s38, v19
  v_mul_u32_u24 v22, 3072, v22
  v_lshl_add_u32 v6, v19, 4, v22
  s_mul_i32 s38, s35, 49152
  s_mul_i32 s39, s33, 192
  s_add_u32 s38, s38, s39
  s_sub_u32 s38, s38, 2048
  v_add_u32 v6, s38, v6
  v_and_b32 v19, 31, v0
  v_lshrrev_b32 v22, 5, v0
  v_bfe_u32 v23, v0, 1, 3
  v_xor_b32 v23, v23, v22
  v_lshlrev_b32 v23, 4, v23
  v_lshl_add_u32 v7, v19, 7, v23
  s_lshl_b32 s38, s35, 12
  v_add_u32 v7, s38, v7
  v_bfe_u32 v19, v0, 2, 2
  v_lshlrev_b32 v9, 11, v22
  v_lshl_add_u32 v9, v19, 8, v9
  v_and_b32 v23, 1, v0
  v_lshl_add_u32 v9, v23, 5, v9
  v_and_b32 v23, 16, v0
  v_add_u32 v9, v23, v9
  v_and_b32 v23, 2, v0
  v_lshl_add_u32 v9, v23, 2, v9
  s_lshl_b32 s38, s36, 1
  v_xor_b32 v23, s38, v19
  v_lshl_add_u32 v9, v23, 6, v9
  v_xor_b32 v10, 64, v9
  v_lshl_add_u32 v19, v22, 3, v19
  v_mul_u32_u24 v19, 192, v19
  v_bfe_u32 v22, v0, 4, 1
  v_mul_u32_u24 v23, 12288, v22
  v_add_u32 v19, v19, v23
  v_and_b32 v23, 1, v0
  v_lshl_add_u32 v19, v23, 4, v19
  v_and_b32 v23, 2, v0
  v_lshl_add_u32 v19, v23, 2, v19
  v_add_u32 v19, 0x10000, v19
  s_mul_i32 s38, s36, 3
  s_add_u32 s39, s38, 0
  v_xor_b32 v23, s39, v22
  v_lshl_add_u32 v11, v23, 5, v19
  s_add_u32 s39, s38, 1
  v_xor_b32 v23, s39, v22
  v_lshl_add_u32 v12, v23, 5, v19
  s_add_u32 s39, s38, 2
  v_xor_b32 v23, s39, v22
  v_lshl_add_u32 v13, v23, 5, v19
  v_add_u32 v9, 0x18000, v9
  v_add_u32 v10, 0x18000, v10
  v_lshrrev_b32 v19, 4, v0
  v_bfe_u32 v22, v0, 2, 2
  v_lshl_add_u32 v19, v19, 3, v22
  v_and_b32 v22, 3, v0
  v_lshlrev_b32 v22, 3, v22
  v_lshl_add_u32 v19, v19, 8, v22
  s_lshl_b32 s38, s34, 5
  v_add_u32 v9, s38, v19
  v_lshlrev_b32 v10, 4, v0
  s_waitcnt vmcnt(16) lgkmcnt(0)
  s_add_u32 s3, s3, 0x9e3779b8
  v_mov_b32 v20, 0
  v_mov_b32 v21, 0
  v_dot2c_f32_bf16 v20, s37, v248
  s_nop 2
  v_dot2c_f32_bf16 v21, v248, v248
  v_dot2c_f32_bf16 v20, s37, v249
  v_dot2c_f32_bf16 v21, v249, v249
  s_nop 2
  v_dot2c_f32_bf16 v20, s37, v250
  v_dot2c_f32_bf16 v21, v250, v250
  v_dot2c_f32_bf16 v20, s37, v251
  s_nop 2
  v_dot2c_f32_bf16 v21, v251, v251
  v_dot2c_f32_bf16 v20, s37, v252
  v_dot2c_f32_bf16 v21, v252, v252
  s_nop 2
  v_permlane32_swap_b32 v20, v21
  v_add_f32 v20, v20, v21
  v_mov_b32 v21, v20
  s_nop 2
  v_permlane16_swap_b32 v20, v21
  v_add_f32 v20, v20, v21
  s_nop 2
  v_add_f32_dpp v20, v20, v20 row_ror:8 row_mask:0xf bank_mask:0xf
  s_nop 2
  v_add_f32_dpp v20, v20, v20 row_ror:4 row_mask:0xf bank_mask:0xf
  s_nop 2
  v_add_f32_dpp v20, v20, v20 row_ror:2 row_mask:0xf bank_mask:0xf
  s_nop 2
  v_add_f32_dpp v20, v20, v20 row_ror:1 row_mask:0xf bank_mask:0xf
  v_mul_f32 v20, 0x3acccccd, v20
  v_mov_b32 v21, v20
  s_nop 2
  v_permlane32_swap_b32 v20, v21
  v_fma_f32 v21, -v20, v20, v21
  v_max_f32 v21, 0, v21
  s_nop 2
  v_cvt_pk_bf16_f32 v20, v20, v21
  v_and_b32 v21, 0xffff0000, v20
  v_add_f32 v21, 0x3727c5ac, v21
  s_nop 2
  v_cvt_pk_bf16_f32 v21, v21, v21
  v_lshlrev_b32 v21, 16, v21
  v_sqrt_f32 v21, v21
  s_nop 2
  v_lshlrev_b32 v20, 16, v20
  v_cvt_pk_bf16_f32 v21, v21, v21
  v_lshlrev_b32 v21, 16, v21
  s_nop 2
  v_rcp_f32 v21, v21
  v_sub_f32 v20, 0, v20
  v_mov_b32 v22, s3
  s_nop 2
  v_mov_b32 v23, s3
  s_nop 2
  s_mov_b64 exec, 1
  buffer_store_dwordx4 v[20:23], off, s[20:23], s69 sc1
  s_mov_b64 exec, -1
  s_min_u32 s38, s34, 1
  s_lshl_b32 s38, s38, 8
  v_lshl_add_u32 v16, v0, 2, s38
  s_mul_i32 s38, s33, 2560
  v_lshl_add_u32 v17, v16, 1, s38
  s_lshl_b32 s38, s32, 2
  s_add_u32 s38, s38, s35
  s_lshl_b32 s38, s38, 9
  s_add_u32 s38, s38, 20971520
  v_and_b32 v19, 31, v0
  v_lshl_add_u32 v18, v19, 4, s38
  s_waitcnt vmcnt(13)
  s_barrier
  v_xor_b32 v8, 131072, v7
  ds_read_b128 v[96:99], v8
  v_xor_b32 v8, 131104, v7
  ds_read_b128 v[100:103], v8
  v_xor_b32 v8, 131136, v7
  ds_read_b128 v[104:107], v8
  v_xor_b32 v8, 131168, v7
  ds_read_b128 v[108:111], v8
  v_add_u32 v14, 147456, v9
  ds_read_b64_tr_b16 v[48:49], v14 offset:0
  ds_read_b64_tr_b16 v[50:51], v14 offset:1024
  ds_read_b64_tr_b16 v[52:53], v14 offset:8192
  ds_read_b64_tr_b16 v[54:55], v14 offset:9216
  s_waitcnt lgkmcnt(0)
  s_add_u32 s39, s32, 0
  s_mul_i32 s38, s39, 205
  s_lshr_b32 s38, s38, 10
  s_mul_i32 s40, s38, 5
  s_sub_u32 s39, s39, s40
  s_lshl_b32 s39, s39, 3
  s_add_u32 s39, s39, s34
  s_mul_i32 s40, s39, 205
  s_lshr_b32 s40, s40, 10
  s_mul_i32 s40, s40, 335
  s_add_u32 s40, s40, s39
  s_mul_i32 s38, s38, 10
  s_add_u32 s40, s40, s38
  s_lshl_b32 s40, s40, 10
  s_add_u32 s40, s40, 17022976
  s_add_u32 s41, s40, 5120
  buffer_store_dwordx4 v[48:51], v10, s[20:23], s40 offen sc1
  buffer_store_dwordx4 v[52:55], v10, s[20:23], s41 offen sc1
  s_waitcnt vmcnt(11)
  s_barrier
  v_xor_b32 v8, 32768, v7
  ds_read_b128 v[112:115], v8
  v_xor_b32 v8, 32800, v7
  ds_read_b128 v[116:119], v8
  v_xor_b32 v8, 32832, v7
  ds_read_b128 v[120:123], v8
  v_xor_b32 v8, 32864, v7
  ds_read_b128 v[124:127], v8
  v_add_u32 v14, 49152, v9
  ds_read_b64_tr_b16 v[56:57], v14 offset:0
  ds_read_b64_tr_b16 v[58:59], v14 offset:1024
  ds_read_b64_tr_b16 v[60:61], v14 offset:8192
  ds_read_b64_tr_b16 v[62:63], v14 offset:9216
  s_add_u32 m0, s46, 131072
  s_lshl_b32 s78, s92, 7
  buffer_load_dwordx4 v1, s[4:7], s78 offen lds
  buffer_load_dwordx4 v2, s[4:7], s78 offen offset:1024 lds
  s_add_u32 s92, s92, 1
  s_cmp_eq_u32 s92, 10
  s_cselect_b32 s92, 0, s92
  s_waitcnt lgkmcnt(0)
  s_add_u32 s39, s32, 16
  s_mul_i32 s38, s39, 205
  s_lshr_b32 s38, s38, 10
  s_mul_i32 s40, s38, 5
  s_sub_u32 s39, s39, s40
  s_lshl_b32 s39, s39, 3
  s_add_u32 s39, s39, s34
  s_mul_i32 s40, s39, 205
  s_lshr_b32 s40, s40, 10
  s_mul_i32 s40, s40, 335
  s_add_u32 s40, s40, s39
  s_mul_i32 s38, s38, 10
  s_add_u32 s40, s40, s38
  s_lshl_b32 s40, s40, 10
  s_add_u32 s40, s40, 17022976
  s_add_u32 s41, s40, 5120
  buffer_store_dwordx4 v[56:59], v10, s[20:23], s40 offen sc1
  buffer_store_dwordx4 v[60:63], v10, s[20:23], s41 offen sc1
  s_waitcnt vmcnt(11)
  s_barrier
  v_xor_b32 v8, 65536, v7
  ds_read_b128 v[128:131], v8
  v_xor_b32 v8, 65568, v7
  ds_read_b128 v[132:135], v8
  v_xor_b32 v8, 65600, v7
  ds_read_b128 v[136:139], v8
  v_xor_b32 v8, 65632, v7
  ds_read_b128 v[140:143], v8
  v_add_u32 v14, 81920, v9
  ds_read_b64_tr_b16 v[48:49], v14 offset:0
  ds_read_b64_tr_b16 v[50:51], v14 offset:1024
  ds_read_b64_tr_b16 v[52:53], v14 offset:8192
  ds_read_b64_tr_b16 v[54:55], v14 offset:9216
  s_add_u32 m0, s46, 32768
  s_lshl_b32 s78, s92, 7
  buffer_load_dwordx4 v1, s[4:7], s78 offen lds
  buffer_load_dwordx4 v2, s[4:7], s78 offen offset:1024 lds
  s_add_u32 s92, s92, 1
  s_cmp_eq_u32 s92, 10
  s_cselect_b32 s92, 0, s92
  s_waitcnt lgkmcnt(0)
  s_add_u32 s39, s32, 32
  s_mul_i32 s38, s39, 205
  s_lshr_b32 s38, s38, 10
  s_mul_i32 s40, s38, 5
  s_sub_u32 s39, s39, s40
  s_lshl_b32 s39, s39, 3
  s_add_u32 s39, s39, s34
  s_mul_i32 s40, s39, 205
  s_lshr_b32 s40, s40, 10
  s_mul_i32 s40, s40, 335
  s_add_u32 s40, s40, s39
  s_mul_i32 s38, s38, 10
  s_add_u32 s40, s40, s38
  s_lshl_b32 s40, s40, 10
  s_add_u32 s40, s40, 17022976
  s_add_u32 s41, s40, 5120
  buffer_store_dwordx4 v[48:51], v10, s[20:23], s40 offen sc1
  buffer_store_dwordx4 v[52:55], v10, s[20:23], s41 offen sc1
  s_waitcnt vmcnt(11)
  s_barrier
  v_xor_b32 v8, 98304, v7
  ds_read_b128 v[144:147], v8
  v_xor_b32 v8, 98336, v7
  ds_read_b128 v[148:151], v8
  v_xor_b32 v8, 98368, v7
  ds_read_b128 v[152:155], v8
  v_xor_b32 v8, 98400, v7
  ds_read_b128 v[156:159], v8
  v_add_u32 v14, 114688, v9
  ds_read_b64_tr_b16 v[56:57], v14 offset:0
  ds_read_b64_tr_b16 v[58:59], v14 offset:1024
  ds_read_b64_tr_b16 v[60:61], v14 offset:8192
  ds_read_b64_tr_b16 v[62:63], v14 offset:9216
  s_add_u32 m0, s46, 65536
  s_lshl_b32 s78, s92, 7
  buffer_load_dwordx4 v1, s[4:7], s78 offen lds
  buffer_load_dwordx4 v2, s[4:7], s78 offen offset:1024 lds
  s_add_u32 s92, s92, 1
  s_cmp_eq_u32 s92, 10
  s_cselect_b32 s92, 0, s92
  s_waitcnt lgkmcnt(0)
  s_add_u32 s39, s32, 48
  s_min_u32 s39, s39, 49
  s_mul_i32 s38, s39, 205
  s_lshr_b32 s38, s38, 10
  s_mul_i32 s40, s38, 5
  s_sub_u32 s39, s39, s40
  s_lshl_b32 s39, s39, 3
  s_add_u32 s39, s39, s34
  s_mul_i32 s40, s39, 205
  s_lshr_b32 s40, s40, 10
  s_mul_i32 s40, s40, 335
  s_add_u32 s40, s40, s39
  s_mul_i32 s38, s38, 10
  s_add_u32 s40, s40, s38
  s_lshl_b32 s40, s40, 10
  s_add_u32 s40, s40, 17022976
  s_add_u32 s41, s40, 5120
  buffer_store_dwordx4 v[56:59], v10, s[20:23], s40 offen sc1
  buffer_store_dwordx4 v[60:63], v10, s[20:23], s41 offen sc1
  s_waitcnt vmcnt(10)
  s_barrier
  v_xor_b32 v8, 131072, v7
  ds_read_b128 v[160:163], v8
  v_xor_b32 v8, 131104, v7
  ds_read_b128 v[164:167], v8
  v_xor_b32 v8, 131136, v7
  ds_read_b128 v[168:171], v8
  v_xor_b32 v8, 131168, v7
  ds_read_b128 v[172:175], v8
  s_add_u32 m0, s46, 98304
  s_lshl_b32 s78, s92, 7
  buffer_load_dwordx4 v1, s[4:7], s78 offen lds
  buffer_load_dwordx4 v2, s[4:7], s78 offen offset:1024 lds
  s_add_u32 s92, s92, 1
  s_cmp_eq_u32 s92, 10
  s_cselect_b32 s92, 0, s92
  s_waitcnt lgkmcnt(0)
  s_waitcnt vmcnt(8)
  s_barrier
  v_xor_b32 v8, 32768, v7
  ds_read_b128 v[176:179], v8
  v_xor_b32 v8, 32800, v7
  ds_read_b128 v[180:183], v8
  v_xor_b32 v8, 32832, v7
  ds_read_b128 v[184:187], v8
  v_xor_b32 v8, 32864, v7
  ds_read_b128 v[188:191], v8
  s_add_u32 m0, s46, 131072
  s_lshl_b32 s78, s92, 7
  buffer_load_dwordx4 v1, s[4:7], s78 offen lds
  buffer_load_dwordx4 v2, s[4:7], s78 offen offset:1024 lds
  s_add_u32 s92, s92, 1
  s_cmp_eq_u32 s92, 10
  s_cselect_b32 s92, 0, s92
  s_waitcnt lgkmcnt(0)
  s_waitcnt vmcnt(6)
  s_barrier
  v_xor_b32 v8, 65536, v7
  ds_read_b128 v[192:195], v8
  v_xor_b32 v8, 65568, v7
  ds_read_b128 v[196:199], v8
  v_xor_b32 v8, 65600, v7
  ds_read_b128 v[200:203], v8
  v_xor_b32 v8, 65632, v7
  ds_read_b128 v[204:207], v8
  buffer_load_dwordx4 v[20:23], v18, s[20:23], 0 offen sc1
  s_add_u32 m0, s46, 32768
  s_lshl_b32 s78, s92, 7
  buffer_load_dwordx4 v1, s[4:7], s78 offen lds
  buffer_load_dwordx4 v2, s[4:7], s78 offen offset:1024 lds
  s_add_u32 s92, s92, 1
  s_cmp_eq_u32 s92, 10
  s_cselect_b32 s92, 0, s92
  s_waitcnt lgkmcnt(0)
  s_waitcnt vmcnt(5)
  s_barrier
  v_xor_b32 v8, 98304, v7
  ds_read_b128 v[208:211], v8
  v_xor_b32 v8, 98336, v7
  ds_read_b128 v[212:215], v8
  v_xor_b32 v8, 98368, v7
  ds_read_b128 v[216:219], v8
  v_xor_b32 v8, 98400, v7
  ds_read_b128 v[220:223], v8
  s_add_u32 m0, s47, 65536
  s_mul_i32 s78, s92, 196608
  buffer_load_dwordx4 v4, s[12:15], s78 offen lds
  buffer_load_dwordx4 v5, s[12:15], s78 offen offset:1024 lds
  buffer_load_dwordx4 v6, s[12:15], s78 offen offset:2048 lds
  s_add_u32 s92, s92, 1
  s_cmp_eq_u32 s92, 10
  s_cselect_b32 s92, 0, s92
  s_waitcnt lgkmcnt(0)
  s_waitcnt vmcnt(6)
  s_barrier
  v_xor_b32 v8, 131072, v7
  ds_read_b128 v[224:227], v8
  v_xor_b32 v8, 131104, v7
  ds_read_b128 v[228:231], v8
  v_xor_b32 v8, 131136, v7
  ds_read_b128 v[232:235], v8
  v_xor_b32 v8, 131168, v7
  ds_read_b128 v[236:239], v8
  s_add_u32 m0, s47, 90112
  s_mul_i32 s78, s92, 196608
  buffer_load_dwordx4 v4, s[12:15], s78 offen lds
  buffer_load_dwordx4 v5, s[12:15], s78 offen offset:1024 lds
  buffer_load_dwordx4 v6, s[12:15], s78 offen offset:2048 lds
  s_add_u32 s92, s92, 1
  s_cmp_eq_u32 s92, 10
  s_cselect_b32 s92, 0, s92
  s_waitcnt lgkmcnt(0)
  s_waitcnt vmcnt(6)
  s_barrier
  v_xor_b32 v8, 32768, v7
  ds_read_b128 v[240:243], v8
  v_xor_b32 v8, 32800, v7
  ds_read_b128 v[244:247], v8
  v_xor_b32 v8, 32832, v7
  ds_read_b128 v[248:251], v8
  v_xor_b32 v8, 32864, v7
  ds_read_b128 v[252:255], v8
  s_add_u32 m0, s47, 114688
  s_mul_i32 s78, s92, 196608
  buffer_load_dwordx4 v4, s[12:15], s78 offen lds
  buffer_load_dwordx4 v5, s[12:15], s78 offen offset:1024 lds
  buffer_load_dwordx4 v6, s[12:15], s78 offen offset:2048 lds
  s_add_u32 s92, s92, 1
  s_cmp_eq_u32 s92, 10
  s_cselect_b32 s92, 0, s92
  s_waitcnt lgkmcnt(0)
  v_cmp_ne_u32 vcc, s3, v22
  s_cbranch_vccnz SP_7
RT_8:
  s_waitcnt vmcnt(6)
  s_barrier
  ds_read_b64_tr_b16 v[32:33], v11 offset:0
  ds_read_b64_tr_b16 v[34:35], v11 offset:768
  s_add_u32 m0, s47, 139264
  s_mul_i32 s78, s92, 196608
  buffer_load_dwordx4 v4, s[12:15], s78 offen lds
  ds_read_b64_tr_b16 v[36:37], v12 offset:0
  ds_read_b64_tr_b16 v[38:39], v12 offset:768
  ds_read_b64_tr_b16 v[40:41], v13 offset:0
  ds_read_b64_tr_b16 v[42:43], v13 offset:768
  ds_read_b64_tr_b16 v[44:45], v11 offset:3072
  ds_read_b64_tr_b16 v[46:47], v11 offset:3840
  buffer_load_dwordx4 v5, s[12:15], s78 offen offset:1024 lds
  ds_read_b64_tr_b16 v[24:25], v12 offset:3072
  ds_read_b64_tr_b16 v[26:27], v12 offset:3840
  ds_read_b64_tr_b16 v[28:29], v13 offset:3072
  ds_read_b64_tr_b16 v[30:31], v13 offset:3840
  s_waitcnt vmcnt(0)
  s_waitcnt lgkmcnt(0)
  s_branch LJ_2
LV_1:
  s_waitcnt lgkmcnt(14)
  v_mfma_f32_32x32x16_bf16 v[48:63], v[96:99], v[24:27], 0
  v_xor_b32 v8, 131168, v7
  ds_read_b128 v[108:111], v8
  ds_read_b64_tr_b16 v[24:25], v9 offset:61440
  ds_read_b64_tr_b16 v[26:27], v9 offset:62464
  s_add_u32 m0, s46, 98304
  s_lshl_b32 s78, s92, 7
  buffer_load_dwordx4 v1, s[4:7], s78 offen lds
  s_waitcnt lgkmcnt(15)
  v_mfma_f32_32x32x16_bf16 v[64:79], v[96:99], v[28:31], 0
  ds_read_b64_tr_b16 v[28:29], v10 offset:61440
  ds_read_b64_tr_b16 v[30:31], v10 offset:62464
  buffer_load_dwordx4 v2, s[4:7], s78 offen offset:1024 lds
  s_waitcnt lgkmcnt(15)
  v_mfma_f32_32x32x16_bf16 v[80:95], v[232:235], v[224:227], 0
  s_waitcnt lgkmcnt(12)
  v_mfma_f32_32x32x16_bf16 v[48:63], v[100:103], v[32:35], v[48:63]
  s_waitcnt vmcnt(6)
  s_barrier
  v_xor_b32 v9, 0x10000, v9
  v_xor_b32 v8, 32768, v7
  ds_read_b128 v[112:115], v8
  ds_read_b64_tr_b16 v[32:33], v9 offset:16384
  ds_read_b64_tr_b16 v[34:35], v9 offset:17408
  s_add_u32 m0, s46, 114688
  s_mul_i32 s78, s92, 245760
  buffer_load_dwordx4 v3, s[8:11], s78 offen lds
  s_add_u32 s92, s92, 1
  s_cmp_eq_u32 s92, 10
  s_cselect_b32 s92, 0, s92
  v_mov_b32 v20, 0
  v_mov_b32 v21, 0
  v_dot2c_f32_bf16 v20, s37, v248
  v_xor_b32 v253, 0x10000, v253
  ds_read_b64_tr_b16 v[228:229], v253 offset:16384
  ds_read_b64_tr_b16 v[230:231], v253 offset:17408
  s_waitcnt lgkmcnt(15)
  v_mfma_f32_32x32x16_bf16 v[64:79], v[100:103], v[36:39], v[64:79]
  v_xor_b32 v10, 0x10000, v10
  ds_read_b64_tr_b16 v[36:37], v10 offset:16384
  ds_read_b64_tr_b16 v[38:39], v10 offset:17408
  s_add_u32 s78, s78, 14336
  buffer_load_dwordx4 v3, s[8:11], s78 offen offset:1024 lds
  v_dot2c_f32_bf16 v21, v248, v248
  v_dot2c_f32_bf16 v20, s37, v249
  v_dot2c_f32_bf16 v21, v249, v249
  s_waitcnt lgkmcnt(14)
  v_mfma_f32_32x32x16_bf16 v[48:63], v[104:107], v[40:43], v[48:63]
  v_xor_b32 v8, 32800, v7
  ds_read_b128 v[116:119], v8
  ds_read_b64_tr_b16 v[40:41], v9 offset:20480
  ds_read_b64_tr_b16 v[42:43], v9 offset:21504
  s_add_u32 m0, s46, 131072
  s_lshl_b32 s78, s92, 7
  buffer_load_dwordx4 v1, s[4:7], s78 offen lds
  v_dot2c_f32_bf16 v20, s37, v250
  v_dot2c_f32_bf16 v21, v250, v250
  v_dot2c_f32_bf16 v20, s37, v251
  s_waitcnt lgkmcnt(15)
  v_mfma_f32_32x32x16_bf16 v[64:79], v[104:107], v[44:47], v[64:79]
  ds_read_b64_tr_b16 v[44:45], v10 offset:20480
  ds_read_b64_tr_b16 v[46:47], v10 offset:21504
  buffer_load_dwordx4 v2, s[4:7], s78 offen offset:1024 lds
  v_dot2c_f32_bf16 v21, v251, v251
  v_dot2c_f32_bf16 v20, s37, v252
  v_dot2c_f32_bf16 v21, v252, v252
  s_waitcnt lgkmcnt(7)
  v_mfma_f32_32x32x16_bf16 v[80:95], v[232:235], v[228:231], v[80:95]
  v_mfma_f32_32x32x16_bf16 v[48:63], v[108:111], v[24:27], v[48:63]
  v_xor_b32 v8, 32832, v7
  ds_read_b128 v[120:123], v8
  ds_read_b64_tr_b16 v[24:25], v9 offset:24576
  ds_read_b64_tr_b16 v[26:27], v9 offset:25600
  s_add_u32 m0, s46, 147456
  s_mul_i32 s78, s92, 245760
  buffer_load_dwordx4 v3, s[8:11], s78 offen lds
  s_add_u32 s92, s92, 1
  s_cmp_eq_u32 s92, 10
  s_cselect_b32 s92, 0, s92
  v_permlane32_swap_b32 v20, v21
  v_add_f32 v20, v20, v21
  v_mov_b32 v21, v20
  v_and_b32 v253, 3, v0
  v_bfe_u32 v224, v0, 2, 1
  v_lshl_add_u32 v253, v224, 4, v253
  v_bfe_u32 v224, v0, 3, 2
  v_lshl_add_u32 v253, v224, 2, v253
  v_mfma_f32_32x32x16_bf16 v[64:79], v[108:111], v[28:31], v[64:79]
  ds_read_b64_tr_b16 v[28:29], v10 offset:24576
  ds_read_b64_tr_b16 v[30:31], v10 offset:25600
  s_add_u32 s78, s78, 14336
  buffer_load_dwordx4 v3, s[8:11], s78 offen offset:1024 lds
  v_permlane16_swap_b32 v20, v21
  v_add_f32 v20, v20, v21
  v_mfma_f32_32x32x16_bf16 v[48:63], v[112:115], v[32:35], v[48:63]
  v_xor_b32 v8, 32864, v7
  ds_read_b128 v[124:127], v8
  ds_read_b64_tr_b16 v[32:33], v9 offset:28672
  ds_read_b64_tr_b16 v[34:35], v9 offset:29696
  v_add_f32_dpp v20, v20, v20 row_ror:8 row_mask:0xf bank_mask:0xf
  s_lshl_b32 s38, s35, 8
  s_lshl_b32 s39, s36, 7
  s_add_u32 s38, s38, s39
  v_lshl_add_u32 v253, v253, 2, s38
  ds_write_b32 v253, v80 offset:4096
  v_lshlrev_b32 v224, 2, v0
  s_waitcnt lgkmcnt(14)
  v_mfma_f32_32x32x16_bf16 v[64:79], v[112:115], v[36:39], v[64:79]
  ds_read_b64_tr_b16 v[36:37], v10 offset:28672
  ds_read_b64_tr_b16 v[38:39], v10 offset:29696
  v_add_f32_dpp v20, v20, v20 row_ror:4 row_mask:0xf bank_mask:0xf
  s_mul_i32 s39, s32, 15
  s_add_u32 s39, s39, s33
  s_mul_i32 s38, s39, 205
  s_lshr_b32 s38, s38, 10
  s_mul_i32 s40, s38, 5
  s_sub_u32 s39, s39, s40
  s_lshl_b32 s40, s38, 3
  s_add_u32 s40, s40, s34
  s_mul_i32 s40, s40, 5120
  s_lshl_b32 s41, s39, 8
  s_add_u32 s40, s40, s41
  v_lshrrev_b32 v254, 4, v0
  v_lshlrev_b32 v254, 10, v254
  v_lshl_add_u32 v254, v0, 4, v254
  s_lshr_b32 s41, s46, 1
  s_add_u32 m0, s41, 16384
  s_lshl_b32 s39, s39, 3
  s_add_u32 s39, s39, s34
  buffer_load_dwordx4 v254, s[16:19], s40 offen lds
  s_mul_i32 s40, s39, 205
  s_lshr_b32 s40, s40, 10
  s_mul_i32 s40, s40, 335
  s_add_u32 s40, s40, s39
  s_mul_i32 s38, s38, 5
  s_add_u32 s40, s40, s38
  s_lshl_b32 s40, s40, 10
  s_add_u32 s68, s40, 16777216
  s_waitcnt lgkmcnt(13)
  v_mfma_f32_32x32x16_bf16 v[48:63], v[116:119], v[40:43], v[48:63]
  s_waitcnt vmcnt(9)
  s_waitcnt lgkmcnt(2)
  s_barrier
  v_xor_b32 v8, 65536, v7
  ds_read_b128 v[128:131], v8
  ds_read_b64_tr_b16 v[40:41], v9 offset:49152
  ds_read_b64_tr_b16 v[42:43], v9 offset:50176
  s_add_u32 m0, s46, 32768
  s_lshl_b32 s78, s92, 7
  buffer_load_dwordx4 v1, s[4:7], s78 offen lds
  v_add_f32_dpp v20, v20, v20 row_ror:2 row_mask:0xf bank_mask:0xf
  ds_read2st64_b32 v[232:233], v224 offset0:16 offset1:17
  ds_read2st64_b32 v[234:235], v224 offset0:18 offset1:19
  v_lshrrev_b32 v253, 5, v0
  v_lshlrev_b32 v253, 8, v253
  v_lshl_add_u32 v253, v0, 3, v253
  v_mfma_f32_32x32x16_bf16 v[64:79], v[116:119], v[44:47], v[64:79]
  ds_read_b64_tr_b16 v[44:45], v10 offset:49152
  ds_read_b64_tr_b16 v[46:47], v10 offset:50176
  v_add_f32_dpp v20, v20, v20 row_ror:1 row_mask:0xf bank_mask:0xf
  v_mul_f32 v20, 0x3acccccd, v20
  v_mov_b32 v21, v20
  v_mfma_f32_32x32x16_bf16 v[48:63], v[120:123], v[24:27], v[48:63]
  v_xor_b32 v8, 65568, v7
  ds_read_b128 v[132:135], v8
  ds_read_b64_tr_b16 v[24:25], v9 offset:53248
  ds_read_b64_tr_b16 v[26:27], v9 offset:54272
  buffer_load_dwordx4 v2, s[4:7], s78 offen offset:1024 lds
  v_permlane32_swap_b32 v20, v21
  v_fma_f32 v21, -v20, v20, v21
  v_max_f32 v21, 0, v21
  v_mfma_f32_32x32x16_bf16 v[64:79], v[120:123], v[28:31], v[64:79]
  ds_read_b64_tr_b16 v[28:29], v10 offset:53248
  ds_read_b64_tr_b16 v[30:31], v10 offset:54272
  v_cvt_pk_bf16_f32 v20, v20, v21
  v_and_b32 v21, 0xffff0000, v20
  v_add_f32 v21, 0x3727c5ac, v21
  s_cmp_lt_u32 s94, 2
  s_cselect_b32 s38, s93, 117440512
  v_add_u32 v253, s38, v253
  s_waitcnt lgkmcnt(7)
  v_add_f32 v232, v232, v233
  v_add_f32 v234, v234, v235
  v_mov_b32 v233, s3
  v_add_f32 v232, v232, v234
  buffer_store_dwordx2 v[232:233], v253, s[20:23], 0 offen offset:0 sc1
  v_mfma_f32_32x32x16_bf16 v[48:63], v[124:127], v[32:35], v[48:63]
  v_xor_b32 v8, 65600, v7
  ds_read_b128 v[136:139], v8
  ds_read_b64_tr_b16 v[32:33], v9 offset:57344
  ds_read_b64_tr_b16 v[34:35], v9 offset:58368
  s_add_u32 m0, s46, 49152
  s_mul_i32 s78, s92, 245760
  buffer_load_dwordx4 v3, s[8:11], s78 offen lds
  s_add_u32 s92, s92, 1
  s_cmp_eq_u32 s92, 10
  s_cselect_b32 s92, 0, s92
  v_cvt_pk_bf16_f32 v21, v21, v21
  v_lshlrev_b32 v21, 16, v21
  v_sqrt_f32 v21, v21
  v_mfma_f32_32x32x16_bf16 v[64:79], v[124:127], v[36:39], v[64:79]
  ds_read_b64_tr_b16 v[36:37], v10 offset:57344
  ds_read_b64_tr_b16 v[38:39], v10 offset:58368
  v_lshlrev_b32 v20, 16, v20
  v_cvt_pk_bf16_f32 v21, v21, v21
  v_lshlrev_b32 v21, 16, v21
  v_mfma_f32_32x32x16_bf16 v[48:63], v[128:131], v[40:43], v[48:63]
  v_xor_b32 v8, 65632, v7
  ds_read_b128 v[140:143], v8
  ds_read_b64_tr_b16 v[40:41], v9 offset:61440
  ds_read_b64_tr_b16 v[42:43], v9 offset:62464
  s_add_u32 s78, s78, 14336
  buffer_load_dwordx4 v3, s[8:11], s78 offen offset:1024 lds
  v_rcp_f32 v21, v21
  v_sub_f32 v20, 0, v20
  v_mov_b32 v22, s3
  s_waitcnt lgkmcnt(13)
  v_mfma_f32_32x32x16_bf16 v[64:79], v[128:131], v[44:47], v[64:79]
  ds_read_b64_tr_b16 v[44:45], v10 offset:61440
  ds_read_b64_tr_b16 v[46:47], v10 offset:62464
  v_mov_b32 v23, s3
  s_waitcnt lgkmcnt(12)
  v_mfma_f32_32x32x16_bf16 v[48:63], v[132:135], v[24:27], v[48:63]
  s_waitcnt vmcnt(10)
  s_barrier
  v_xor_b32 v9, 0x10000, v9
  v_xor_b32 v8, 98304, v7
  ds_read_b128 v[144:147], v8
  ds_read_b64_tr_b16 v[24:25], v9 offset:16384
  ds_read_b64_tr_b16 v[26:27], v9 offset:17408
  s_add_u32 m0, s46, 65536
  s_lshl_b32 s78, s92, 7
  buffer_load_dwordx4 v1, s[4:7], s78 offen lds
  s_mov_b64 exec, 1
  buffer_store_dwordx4 v[20:23], off, s[20:23], s69 sc1
  s_mov_b64 exec, -1
  s_waitcnt lgkmcnt(13)
  v_mfma_f32_32x32x16_bf16 v[64:79], v[132:135], v[28:31], v[64:79]
  v_xor_b32 v10, 0x10000, v10
  ds_read_b64_tr_b16 v[28:29], v10 offset:16384
  ds_read_b64_tr_b16 v[30:31], v10 offset:17408
  s_waitcnt lgkmcnt(12)
  v_mfma_f32_32x32x16_bf16 v[48:63], v[136:139], v[32:35], v[48:63]
  v_xor_b32 v8, 98336, v7
  ds_read_b128 v[148:151], v8
  ds_read_b64_tr_b16 v[32:33], v9 offset:20480
  ds_read_b64_tr_b16 v[34:35], v9 offset:21504
  buffer_load_dwordx4 v2, s[4:7], s78 offen offset:1024 lds
  s_waitcnt lgkmcnt(13)
  v_mfma_f32_32x32x16_bf16 v[64:79], v[136:139], v[36:39], v[64:79]
  ds_read_b64_tr_b16 v[36:37], v10 offset:20480
  ds_read_b64_tr_b16 v[38:39], v10 offset:21504
  s_waitcnt lgkmcnt(12)
  v_mfma_f32_32x32x16_bf16 v[48:63], v[140:143], v[40:43], v[48:63]
  v_xor_b32 v8, 98368, v7
  ds_read_b128 v[152:155], v8
  ds_read_b64_tr_b16 v[40:41], v9 offset:24576
  ds_read_b64_tr_b16 v[42:43], v9 offset:25600
  s_add_u32 m0, s46, 81920
  s_mul_i32 s78, s92, 245760
  buffer_load_dwordx4 v3, s[8:11], s78 offen lds
  s_add_u32 s92, s92, 1
  s_cmp_eq_u32 s92, 10
  s_cselect_b32 s92, 0, s92
  s_waitcnt lgkmcnt(13)
  v_mfma_f32_32x32x16_bf16 v[64:79], v[140:143], v[44:47], v[64:79]
  ds_read_b64_tr_b16 v[44:45], v10 offset:24576
  ds_read_b64_tr_b16 v[46:47], v10 offset:25600
  s_waitcnt lgkmcnt(12)
  v_mfma_f32_32x32x16_bf16 v[48:63], v[144:147], v[24:27], v[48:63]
  v_xor_b32 v8, 98400, v7
  ds_read_b128 v[156:159], v8
  ds_read_b64_tr_b16 v[24:25], v9 offset:28672
  ds_read_b64_tr_b16 v[26:27], v9 offset:29696
  s_add_u32 s78, s78, 14336
  buffer_load_dwordx4 v3, s[8:11], s78 offen offset:1024 lds
  s_waitcnt lgkmcnt(13)
  v_mfma_f32_32x32x16_bf16 v[64:79], v[144:147], v[28:31], v[64:79]
  ds_read_b64_tr_b16 v[28:29], v10 offset:28672
  ds_read_b64_tr_b16 v[30:31], v10 offset:29696
  s_waitcnt lgkmcnt(12)
  v_mfma_f32_32x32x16_bf16 v[48:63], v[148:151], v[32:35], v[48:63]
  s_waitcnt vmcnt(11)
  s_barrier
  v_xor_b32 v8, 131072, v7
  ds_read_b128 v[160:163], v8
  ds_read_b64_tr_b16 v[32:33], v9 offset:49152
  ds_read_b64_tr_b16 v[34:35], v9 offset:50176
  s_add_u32 m0, s46, 98304
  s_lshl_b32 s78, s92, 7
  buffer_load_dwordx4 v1, s[4:7], s78 offen lds
  s_waitcnt lgkmcnt(13)
  v_mfma_f32_32x32x16_bf16 v[64:79], v[148:151], v[36:39], v[64:79]
  ds_read_b64_tr_b16 v[36:37], v10 offset:49152
  ds_read_b64_tr_b16 v[38:39], v10 offset:50176
  s_waitcnt lgkmcnt(12)
  v_mfma_f32_32x32x16_bf16 v[48:63], v[152:155], v[40:43], v[48:63]
  v_xor_b32 v8, 131104, v7
  ds_read_b128 v[164:167], v8
  ds_read_b64_tr_b16 v[40:41], v9 offset:53248
  ds_read_b64_tr_b16 v[42:43], v9 offset:54272
  buffer_load_dwordx4 v2, s[4:7], s78 offen offset:1024 lds
  s_waitcnt lgkmcnt(13)
  v_mfma_f32_32x32x16_bf16 v[64:79], v[152:155], v[44:47], v[64:79]
  ds_read_b64_tr_b16 v[44:45], v10 offset:53248
  ds_read_b64_tr_b16 v[46:47], v10 offset:54272
  s_waitcnt lgkmcnt(12)
  v_mfma_f32_32x32x16_bf16 v[48:63], v[156:159], v[24:27], v[48:63]
  v_xor_b32 v8, 131136, v7
  ds_read_b128 v[168:171], v8
  ds_read_b64_tr_b16 v[24:25], v9 offset:57344
  ds_read_b64_tr_b16 v[26:27], v9 offset:58368
  s_add_u32 m0, s46, 114688
  s_mul_i32 s78, s92, 245760
  buffer_load_dwordx4 v3, s[8:11], s78 offen lds
  s_add_u32 s92, s92, 1
  s_cmp_eq_u32 s92, 10
  s_cselect_b32 s92, 0, s92
  s_waitcnt lgkmcnt(13)
  v_mfma_f32_32x32x16_bf16 v[64:79], v[156:159], v[28:31], v[64:79]
  ds_read_b64_tr_b16 v[28:29], v10 offset:57344
  ds_read_b64_tr_b16 v[30:31], v10 offset:58368
  s_waitcnt lgkmcnt(12)
  v_mfma_f32_32x32x16_bf16 v[48:63], v[160:163], v[32:35], v[48:63]
  v_xor_b32 v8, 131168, v7
  ds_read_b128 v[172:175], v8
  ds_read_b64_tr_b16 v[32:33], v9 offset:61440
  ds_read_b64_tr_b16 v[34:35], v9 offset:62464
  s_add_u32 s78, s78, 14336
  buffer_load_dwordx4 v3, s[8:11], s78 offen offset:1024 lds
  s_waitcnt lgkmcnt(13)
  v_mfma_f32_32x32x16_bf16 v[64:79], v[160:163], v[36:39], v[64:79]
  ds_read_b64_tr_b16 v[36:37], v10 offset:61440
  ds_read_b64_tr_b16 v[38:39], v10 offset:62464
  s_waitcnt lgkmcnt(12)
  v_mfma_f32_32x32x16_bf16 v[48:63], v[164:167], v[40:43], v[48:63]
  s_waitcnt vmcnt(9)
  s_barrier
  v_xor_b32 v9, 0x10000, v9
  v_xor_b32 v8, 32768, v7
  ds_read_b128 v[176:179], v8
  ds_read_b64_tr_b16 v[40:41], v9 offset:16384
  ds_read_b64_tr_b16 v[42:43], v9 offset:17408
  s_add_u32 m0, s46, 131072
  s_lshl_b32 s78, s92, 7
  buffer_load_dwordx4 v1, s[4:7], s78 offen lds
  s_waitcnt lgkmcnt(13)
  v_mfma_f32_32x32x16_bf16 v[64:79], v[164:167], v[44:47], v[64:79]
  v_xor_b32 v10, 0x10000, v10
  ds_read_b64_tr_b16 v[44:45], v10 offset:16384
  ds_read_b64_tr_b16 v[46:47], v10 offset:17408
  s_waitcnt lgkmcnt(12)
  v_mfma_f32_32x32x16_bf16 v[48:63], v[168:171], v[24:27], v[48:63]
  v_xor_b32 v8, 32800, v7
  ds_read_b128 v[180:183], v8
  ds_read_b64_tr_b16 v[24:25], v9 offset:20480
  ds_read_b64_tr_b16 v[26:27], v9 offset:21504
  buffer_load_dwordx4 v2, s[4:7], s78 offen offset:1024 lds
  s_waitcnt lgkmcnt(13)
  v_mfma_f32_32x32x16_bf16 v[64:79], v[168:171], v[28:31], v[64:79]
  ds_read_b64_tr_b16 v[28:29], v10 offset:20480
  ds_read_b64_tr_b16 v[30:31], v10 offset:21504
  s_waitcnt lgkmcnt(12)
  v_mfma_f32_32x32x16_bf16 v[48:63], v[172:175], v[32:35], v[48:63]
  v_xor_b32 v8, 32832, v7
  ds_read_b128 v[184:187], v8
  ds_read_b64_tr_b16 v[32:33], v9 offset:24576
  ds_read_b64_tr_b16 v[34:35], v9 offset:25600
  s_add_u32 m0, s46, 147456
  s_mul_i32 s78, s92, 245760
  buffer_load_dwordx4 v3, s[8:11], s78 offen lds
  s_add_u32 s92, s92, 1
  s_cmp_eq_u32 s92, 10
  s_cselect_b32 s92, 0, s92
  s_waitcnt lgkmcnt(13)
  v_mfma_f32_32x32x16_bf16 v[64:79], v[172:175], v[36:39], v[64:79]
  ds_read_b64_tr_b16 v[36:37], v10 offset:24576
  ds_read_b64_tr_b16 v[38:39], v10 offset:25600
  s_waitcnt lgkmcnt(12)
  v_mfma_f32_32x32x16_bf16 v[48:63], v[176:179], v[40:43], v[48:63]
  v_xor_b32 v8, 32864, v7
  ds_read_b128 v[188:191], v8
  ds_read_b64_tr_b16 v[40:41], v9 offset:28672
  ds_read_b64_tr_b16 v[42:43], v9 offset:29696
  s_add_u32 s78, s78, 14336
  buffer_load_dwordx4 v3, s[8:11], s78 offen offset:1024 lds
  s_waitcnt lgkmcnt(13)
  v_mfma_f32_32x32x16_bf16 v[64:79], v[176:179], v[44:47], v[64:79]
  ds_read_b64_tr_b16 v[44:45], v10 offset:28672
  ds_read_b64_tr_b16 v[46:47], v10 offset:29696
  s_waitcnt lgkmcnt(12)
  v_mfma_f32_32x32x16_bf16 v[48:63], v[180:183], v[24:27], v[48:63]
  s_waitcnt vmcnt(8)
  s_barrier
  v_xor_b32 v8, 65536, v7
  ds_read_b128 v[192:195], v8
  ds_read_b64_tr_b16 v[24:25], v9 offset:49152
  ds_read_b64_tr_b16 v[26:27], v9 offset:50176
  s_add_u32 m0, s46, 32768
  s_lshl_b32 s78, s92, 7
  buffer_load_dwordx4 v1, s[4:7], s78 offen lds
  s_min_u32 s38, s34, 1
  s_lshl_b32 s38, s38, 8
  v_lshl_add_u32 v16, v0, 2, s38
  s_mul_i32 s38, s33, 2560
  v_lshl_add_u32 v17, v16, 1, s38
  s_lshl_b32 s38, s32, 2
  s_add_u32 s38, s38, s35
  s_lshl_b32 s38, s38, 9
  s_add_u32 s38, s38, 20971520
  v_and_b32 v19, 31, v0
  v_lshl_add_u32 v18, v19, 4, s38
  s_waitcnt lgkmcnt(13)
  v_mfma_f32_32x32x16_bf16 v[64:79], v[180:183], v[28:31], v[64:79]
  ds_read_b64_tr_b16 v[28:29], v10 offset:49152
  ds_read_b64_tr_b16 v[30:31], v10 offset:50176
  s_mov_b32 s38, 21037056
  buffer_load_dwordx2 v[80:81], v17, s[20:23], s38 offen sc1
  s_waitcnt lgkmcnt(12)
  v_mfma_f32_32x32x16_bf16 v[48:63], v[184:187], v[32:35], v[48:63]
  v_xor_b32 v8, 65568, v7
  ds_read_b128 v[196:199], v8
  ds_read_b64_tr_b16 v[32:33], v9 offset:53248
  ds_read_b64_tr_b16 v[34:35], v9 offset:54272
  buffer_load_dwordx4 v2, s[4:7], s78 offen offset:1024 lds
  s_waitcnt lgkmcnt(13)
  v_mfma_f32_32x32x16_bf16 v[64:79], v[184:187], v[36:39], v[64:79]
  ds_read_b64_tr_b16 v[36:37], v10 offset:53248
  ds_read_b64_tr_b16 v[38:39], v10 offset:54272
  s_mov_b32 s38, 21078016
  buffer_load_dwordx2 v[82:83], v17, s[20:23], s38 offen sc1
  s_waitcnt lgkmcnt(12)
  v_mfma_f32_32x32x16_bf16 v[48:63], v[188:191], v[40:43], v[48:63]
  v_xor_b32 v8, 65600, v7
  ds_read_b128 v[200:203], v8
  ds_read_b64_tr_b16 v[40:41], v9 offset:57344
  ds_read_b64_tr_b16 v[42:43], v9 offset:58368
  s_add_u32 m0, s46, 49152
  s_mul_i32 s78, s92, 245760
  buffer_load_dwordx4 v3, s[8:11], s78 offen lds
  s_add_u32 s92, s92, 1
  s_cmp_eq_u32 s92, 10
  s_cselect_b32 s92, 0, s92
  s_waitcnt lgkmcnt(13)
  v_mfma_f32_32x32x16_bf16 v[64:79], v[188:191], v[44:47], v[64:79]
  ds_read_b64_tr_b16 v[44:45], v10 offset:57344
  ds_read_b64_tr_b16 v[46:47], v10 offset:58368
  s_mov_b32 s38, 21118976
  buffer_load_dwordx2 v[84:85], v17, s[20:23], s38 offen sc1
  s_waitcnt lgkmcnt(12)
  v_mfma_f32_32x32x16_bf16 v[48:63], v[192:195], v[24:27], v[48:63]
  v_xor_b32 v8, 65632, v7
  ds_read_b128 v[204:207], v8
  ds_read_b64_tr_b16 v[24:25], v9 offset:61440
  ds_read_b64_tr_b16 v[26:27], v9 offset:62464
  s_add_u32 s78, s78, 14336
  buffer_load_dwordx4 v3, s[8:11], s78 offen offset:1024 lds
  s_waitcnt lgkmcnt(13)
  v_mfma_f32_32x32x16_bf16 v[64:79], v[192:195], v[28:31], v[64:79]
  ds_read_b64_tr_b16 v[28:29], v10 offset:61440
  ds_read_b64_tr_b16 v[30:31], v10 offset:62464
  s_mov_b32 s38, 21159936
  buffer_load_dwordx2 v[86:87], v17, s[20:23], s38 offen sc1
  s_waitcnt lgkmcnt(12)
  v_mfma_f32_32x32x16_bf16 v[48:63], v[196:199], v[32:35], v[48:63]
  s_waitcnt vmcnt(12)
  s_barrier
  v_xor_b32 v9, 0x10000, v9
  v_xor_b32 v8, 98304, v7
  ds_read_b128 v[208:211], v8
  ds_read_b64_tr_b16 v[32:33], v9 offset:16384
  ds_read_b64_tr_b16 v[34:35], v9 offset:17408
  s_add_u32 m0, s47, 65536
  s_mul_i32 s78, s92, 196608
  buffer_load_dwordx4 v4, s[12:15], s78 offen lds
  s_waitcnt lgkmcnt(13)
  v_mfma_f32_32x32x16_bf16 v[64:79], v[196:199], v[36:39], v[64:79]
  v_xor_b32 v10, 0x10000, v10
  ds_read_b64_tr_b16 v[36:37], v10 offset:16384
  ds_read_b64_tr_b16 v[38:39], v10 offset:17408
  s_mov_b32 s38, 21200896
  buffer_load_dwordx2 v[88:89], v17, s[20:23], s38 offen sc1
  s_waitcnt lgkmcnt(12)
  v_mfma_f32_32x32x16_bf16 v[48:63], v[200:203], v[40:43], v[48:63]
  v_xor_b32 v8, 98336, v7
  ds_read_b128 v[212:215], v8
  ds_read_b64_tr_b16 v[40:41], v9 offset:20480
  ds_read_b64_tr_b16 v[42:43], v9 offset:21504
  buffer_load_dwordx4 v5, s[12:15], s78 offen offset:1024 lds
  s_waitcnt lgkmcnt(13)
  v_mfma_f32_32x32x16_bf16 v[64:79], v[200:203], v[44:47], v[64:79]
  ds_read_b64_tr_b16 v[44:45], v10 offset:20480
  ds_read_b64_tr_b16 v[46:47], v10 offset:21504
  buffer_load_dwordx4 v[20:23], v18, s[20:23], 0 offen sc1
  s_waitcnt lgkmcnt(12)
  v_mfma_f32_32x32x16_bf16 v[48:63], v[204:207], v[24:27], v[48:63]
  v_xor_b32 v8, 98368, v7
  ds_read_b128 v[216:219], v8
  ds_read_b64_tr_b16 v[24:25], v9 offset:24576
  ds_read_b64_tr_b16 v[26:27], v9 offset:25600
  buffer_load_dwordx4 v6, s[12:15], s78 offen offset:2048 lds
  s_add_u32 s92, s92, 1
  s_cmp_eq_u32 s92, 10
  s_cselect_b32 s92, 0, s92
  s_waitcnt lgkmcnt(13)
  v_mfma_f32_32x32x16_bf16 v[64:79], v[204:207], v[28:31], v[64:79]
  ds_read_b64_tr_b16 v[28:29], v10 offset:24576
  ds_read_b64_tr_b16 v[30:31], v10 offset:25600
  s_waitcnt lgkmcnt(12)
  v_mfma_f32_32x32x16_bf16 v[48:63], v[208:211], v[32:35], v[48:63]
  v_xor_b32 v8, 98400, v7
  ds_read_b128 v[220:223], v8
  ds_read_b64_tr_b16 v[32:33], v9 offset:28672
  ds_read_b64_tr_b16 v[34:35], v9 offset:29696
  s_waitcnt lgkmcnt(13)
  v_mfma_f32_32x32x16_bf16 v[64:79], v[208:211], v[36:39], v[64:79]
  ds_read_b64_tr_b16 v[36:37], v10 offset:28672
  ds_read_b64_tr_b16 v[38:39], v10 offset:29696
  s_waitcnt lgkmcnt(12)
  v_mfma_f32_32x32x16_bf16 v[48:63], v[212:215], v[40:43], v[48:63]
  s_waitcnt vmcnt(13)
  s_barrier
  v_xor_b32 v8, 131072, v7
  ds_read_b128 v[224:227], v8
  ds_read_b64_tr_b16 v[40:41], v9 offset:49152
  ds_read_b64_tr_b16 v[42:43], v9 offset:50176
  s_add_u32 m0, s47, 90112
  s_mul_i32 s78, s92, 196608
  buffer_load_dwordx4 v4, s[12:15], s78 offen lds
  s_waitcnt lgkmcnt(13)
  v_mfma_f32_32x32x16_bf16 v[64:79], v[212:215], v[44:47], v[64:79]
  ds_read_b64_tr_b16 v[44:45], v10 offset:49152
  ds_read_b64_tr_b16 v[46:47], v10 offset:50176
  s_waitcnt lgkmcnt(12)
  v_mfma_f32_32x32x16_bf16 v[48:63], v[216:219], v[24:27], v[48:63]
  v_xor_b32 v8, 131104, v7
  ds_read_b128 v[228:231], v8
  ds_read_b64_tr_b16 v[24:25], v9 offset:53248
  ds_read_b64_tr_b16 v[26:27], v9 offset:54272
  buffer_load_dwordx4 v5, s[12:15], s78 offen offset:1024 lds
  s_waitcnt lgkmcnt(13)
  v_mfma_f32_32x32x16_bf16 v[64:79], v[216:219], v[28:31], v[64:79]
  ds_read_b64_tr_b16 v[28:29], v10 offset:53248
  ds_read_b64_tr_b16 v[30:31], v10 offset:54272
  s_waitcnt lgkmcnt(12)
  v_mfma_f32_32x32x16_bf16 v[48:63], v[220:223], v[32:35], v[48:63]
  v_xor_b32 v8, 131136, v7
  ds_read_b128 v[232:235], v8
  ds_read_b64_tr_b16 v[32:33], v9 offset:57344
  ds_read_b64_tr_b16 v[34:35], v9 offset:58368
  buffer_load_dwordx4 v6, s[12:15], s78 offen offset:2048 lds
  s_add_u32 s92, s92, 1
  s_cmp_eq_u32 s92, 10
  s_cselect_b32 s92, 0, s92
  s_waitcnt lgkmcnt(13)
  v_mfma_f32_32x32x16_bf16 v[64:79], v[220:223], v[36:39], v[64:79]
  ds_read_b64_tr_b16 v[36:37], v10 offset:57344
  ds_read_b64_tr_b16 v[38:39], v10 offset:58368
  s_waitcnt lgkmcnt(12)
  v_mfma_f32_32x32x16_bf16 v[48:63], v[224:227], v[40:43], v[48:63]
  v_xor_b32 v8, 131168, v7
  ds_read_b128 v[236:239], v8
  ds_read_b64_tr_b16 v[40:41], v9 offset:61440
  ds_read_b64_tr_b16 v[42:43], v9 offset:62464
  s_waitcnt lgkmcnt(13)
  v_mfma_f32_32x32x16_bf16 v[64:79], v[224:227], v[44:47], v[64:79]
  ds_read_b64_tr_b16 v[44:45], v10 offset:61440
  ds_read_b64_tr_b16 v[46:47], v10 offset:62464
  s_waitcnt lgkmcnt(12)
  v_mfma_f32_32x32x16_bf16 v[48:63], v[228:231], v[24:27], v[48:63]
  s_waitcnt vmcnt(9)
  s_barrier
  v_xor_b32 v9, 0x10000, v9
  v_xor_b32 v8, 32768, v7
  ds_read_b128 v[240:243], v8
  ds_read_b64_tr_b16 v[24:25], v9 offset:16384
  ds_read_b64_tr_b16 v[26:27], v9 offset:17408
  s_add_u32 m0, s47, 114688
  s_mul_i32 s78, s92, 196608
  buffer_load_dwordx4 v4, s[12:15], s78 offen lds
  s_waitcnt lgkmcnt(13)
  v_mfma_f32_32x32x16_bf16 v[64:79], v[228:231], v[28:31], v[64:79]
  v_xor_b32 v10, 0x10000, v10
  ds_read_b64_tr_b16 v[28:29], v10 offset:16384
  ds_read_b64_tr_b16 v[30:31], v10 offset:17408
  s_waitcnt lgkmcnt(12)
  v_mfma_f32_32x32x16_bf16 v[48:63], v[232:235], v[32:35], v[48:63]
  v_xor_b32 v8, 32800, v7
  ds_read_b128 v[244:247], v8
  ds_read_b64_tr_b16 v[32:33], v9 offset:20480
  ds_read_b64_tr_b16 v[34:35], v9 offset:21504
  buffer_load_dwordx4 v5, s[12:15], s78 offen offset:1024 lds
  s_waitcnt lgkmcnt(13)
  v_mfma_f32_32x32x16_bf16 v[64:79], v[232:235], v[36:39], v[64:79]
  ds_read_b64_tr_b16 v[36:37], v10 offset:20480
  ds_read_b64_tr_b16 v[38:39], v10 offset:21504
  s_waitcnt lgkmcnt(12)
  v_mfma_f32_32x32x16_bf16 v[48:63], v[236:239], v[40:43], v[48:63]
  v_xor_b32 v8, 32832, v7
  ds_read_b128 v[248:251], v8
  ds_read_b64_tr_b16 v[40:41], v9 offset:24576
  ds_read_b64_tr_b16 v[42:43], v9 offset:25600
  buffer_load_dwordx4 v6, s[12:15], s78 offen offset:2048 lds
  s_add_u32 s92, s92, 1
  s_cmp_eq_u32 s92, 10
  s_cselect_b32 s92, 0, s92
  s_waitcnt vmcnt(7)
  v_xor_b32 v81, s3, v81
  v_xor_b32 v83, s3, v83
  v_xor_b32 v85, s3, v85
  v_xor_b32 v87, s3, v87
  v_xor_b32 v89, s3, v89
  v_xor_b32 v22, s3, v22
  v_or_b32 v81, v81, v22
  v_or3_b32 v81, v81, v83, v85
  v_or3_b32 v81, v81, v87, v89
  v_cmp_ne_u32 vcc, 0, v81
  s_cbranch_vccnz SP_10
RT_11:
  v_add_f32 v80, v80, v82
  v_add_f32 v84, v84, v86
  v_add_f32 v80, v80, v88
  v_add_f32 v80, v80, v84
  ds_write_b32 v16, v80 offset:0
  s_waitcnt lgkmcnt(14)
  v_mfma_f32_32x32x16_bf16 v[64:79], v[236:239], v[44:47], v[64:79]
  ds_read_b64_tr_b16 v[44:45], v10 offset:24576
  ds_read_b64_tr_b16 v[46:47], v10 offset:25600
  s_waitcnt lgkmcnt(13)
  v_mfma_f32_32x32x16_bf16 v[48:63], v[240:243], v[24:27], v[48:63]
  v_xor_b32 v8, 32864, v7
  ds_read_b128 v[252:255], v8
  ds_read_b64_tr_b16 v[24:25], v9 offset:28672
  ds_read_b64_tr_b16 v[26:27], v9 offset:29696
  s_waitcnt lgkmcnt(14)
  v_mfma_f32_32x32x16_bf16 v[64:79], v[240:243], v[28:31], v[64:79]
  ds_read_b64_tr_b16 v[28:29], v10 offset:28672
  ds_read_b64_tr_b16 v[30:31], v10 offset:29696
  s_waitcnt lgkmcnt(13)
  v_mfma_f32_32x32x16_bf16 v[48:63], v[244:247], v[32:35], v[48:63]
  s_waitcnt vmcnt(6)
  s_waitcnt lgkmcnt(7)
  s_barrier
  ds_read_b64_tr_b16 v[32:33], v11 offset:0
  ds_read_b64_tr_b16 v[34:35], v11 offset:768
  s_add_u32 m0, s47, 139264
  s_mul_i32 s78, s92, 196608
  buffer_load_dwordx4 v4, s[12:15], s78 offen lds
  v_mfma_f32_32x32x16_bf16 v[64:79], v[244:247], v[36:39], v[64:79]
  ds_read_b64_tr_b16 v[36:37], v12 offset:0
  ds_read_b64_tr_b16 v[38:39], v12 offset:768
  v_mfma_f32_32x32x16_bf16 v[48:63], v[248:251], v[40:43], v[48:63]
  ds_read_b64_tr_b16 v[40:41], v13 offset:0
  ds_read_b64_tr_b16 v[42:43], v13 offset:768
  s_waitcnt lgkmcnt(11)
  v_mfma_f32_32x32x16_bf16 v[64:79], v[248:251], v[44:47], v[64:79]
  ds_read_b64_tr_b16 v[44:45], v11 offset:3072
  ds_read_b64_tr_b16 v[46:47], v11 offset:3840
  buffer_load_dwordx4 v5, s[12:15], s78 offen offset:1024 lds
  s_waitcnt lgkmcnt(10)
  v_mfma_f32_32x32x16_bf16 v[48:63], v[252:255], v[24:27], v[48:63]
  ds_read_b64_tr_b16 v[24:25], v12 offset:3072
  ds_read_b64_tr_b16 v[26:27], v12 offset:3840
  s_waitcnt lgkmcnt(10)
  v_mfma_f32_32x32x16_bf16 v[64:79], v[252:255], v[28:31], v[64:79]
  ds_read_b64_tr_b16 v[28:29], v13 offset:3072
  ds_read_b64_tr_b16 v[30:31], v13 offset:3840
  s_lshl_b32 s39, s35, 7
  s_lshl_b32 s38, s36, 8
  v_and_b32 v19, 3, v0
  v_bfe_u32 v22, v0, 2, 1
  v_lshl_add_u32 v19, v22, 4, v19
  v_bfe_u32 v22, v0, 3, 2
  v_lshl_add_u32 v19, v22, 2, v19
  v_lshl_add_u32 v9, v19, 2, s38
  ds_read_b32 v16, v9 offset:0
  ds_read_b32 v14, v9 offset:128
  v_and_b32 v23, 31, v0
  v_lshl_add_u32 v23, v23, 2, s39
  v_mul_f32 v15, v20, v21
  ds_write_b32 v23, v21 offset:2048
  ds_write_b32 v23, v15 offset:2560
  v_lshrrev_b32 v22, 5, v0
  v_lshl_add_u32 v23, v22, 4, s39
  s_sub_u32 s40, s33, 10
  s_lshl_b32 s40, s40, 7
  s_lshl_b32 s41, s36, 6
  s_add_u32 s40, s40, s41
  s_lshl_b32 s41, s32, 2
  s_add_u32 s41, s41, s35
  s_mul_i32 s41, s41, 5120
  s_add_u32 s41, s41, 2624000
  v_mul_u32_u24 v22, 640, v22
  s_mov_b32 s42, 327040
  v_add_u32 v7, s40, v19
  v_mul_u32_u24 v9, 1639, v7
  v_lshrrev_b32 v9, 16, v9
  v_lshl_add_u32 v7, v7, 4, v22
  v_mad_u32_u24 v7, v9, s42, v7
  v_add_u32 v8, s40, v19
  v_add_u32 v8, 32, v8
  v_mul_u32_u24 v9, 1639, v8
  v_lshrrev_b32 v9, 16, v9
  v_lshl_add_u32 v8, v8, 4, v22
  v_mad_u32_u24 v8, v9, s42, v8
  s_waitcnt lgkmcnt(0)
  ds_read_b128 v[80:83], v23 offset:2048
  ds_read_b128 v[88:91], v23 offset:2560
  ds_read_b128 v[84:87], v23 offset:2080
  ds_read_b128 v[92:95], v23 offset:2592
  s_waitcnt lgkmcnt(0)
  v_pk_mul_f32 v[48:49], v[48:49], v[80:81]
  v_pk_mul_f32 v[50:51], v[50:51], v[82:83]
  v_pk_mul_f32 v[52:53], v[52:53], v[84:85]
  v_pk_mul_f32 v[54:55], v[54:55], v[86:87]
  v_pk_fma_f32 v[48:49], v[88:89], v[16:17], v[48:49] op_sel_hi:[1,0,1]
  v_pk_fma_f32 v[50:51], v[90:91], v[16:17], v[50:51] op_sel_hi:[1,0,1]
  v_pk_fma_f32 v[52:53], v[92:93], v[16:17], v[52:53] op_sel_hi:[1,0,1]
  v_pk_fma_f32 v[54:55], v[94:95], v[16:17], v[54:55] op_sel_hi:[1,0,1]
  v_cvt_pk_bf16_f32 v48, v48, v49
  v_cvt_pk_bf16_f32 v49, v50, v51
  v_cvt_pk_bf16_f32 v50, v52, v53
  v_cvt_pk_bf16_f32 v51, v54, v55
  buffer_store_dwordx4 v[48:51], v7, s[20:23], s41 offen offset:0 sc1
  v_pk_mul_f32 v[64:65], v[64:65], v[80:81]
  v_pk_mul_f32 v[66:67], v[66:67], v[82:83]
  v_pk_mul_f32 v[68:69], v[68:69], v[84:85]
  v_pk_mul_f32 v[70:71], v[70:71], v[86:87]
  v_pk_fma_f32 v[64:65], v[88:89], v[14:15], v[64:65] op_sel_hi:[1,0,1]
  v_pk_fma_f32 v[66:67], v[90:91], v[14:15], v[66:67] op_sel_hi:[1,0,1]
  v_pk_fma_f32 v[68:69], v[92:93], v[14:15], v[68:69] op_sel_hi:[1,0,1]
  v_pk_fma_f32 v[70:71], v[94:95], v[14:15], v[70:71] op_sel_hi:[1,0,1]
  v_cvt_pk_bf16_f32 v64, v64, v65
  v_cvt_pk_bf16_f32 v65, v66, v67
  v_cvt_pk_bf16_f32 v66, v68, v69
  v_cvt_pk_bf16_f32 v67, v70, v71
  buffer_store_dwordx4 v[64:67], v8, s[20:23], s41 offen offset:0 sc1
  s_waitcnt lgkmcnt(0)
  ds_read_b128 v[80:83], v23 offset:2112
  ds_read_b128 v[88:91], v23 offset:2624
  ds_read_b128 v[84:87], v23 offset:2144
  ds_read_b128 v[92:95], v23 offset:2656
  s_waitcnt lgkmcnt(0)
  v_pk_mul_f32 v[56:57], v[56:57], v[80:81]
  v_pk_mul_f32 v[58:59], v[58:59], v[82:83]
  v_pk_mul_f32 v[60:61], v[60:61], v[84:85]
  v_pk_mul_f32 v[62:63], v[62:63], v[86:87]
  v_pk_fma_f32 v[56:57], v[88:89], v[16:17], v[56:57] op_sel_hi:[1,0,1]
  v_pk_fma_f32 v[58:59], v[90:91], v[16:17], v[58:59] op_sel_hi:[1,0,1]
  v_pk_fma_f32 v[60:61], v[92:93], v[16:17], v[60:61] op_sel_hi:[1,0,1]
  v_pk_fma_f32 v[62:63], v[94:95], v[16:17], v[62:63] op_sel_hi:[1,0,1]
  v_cvt_pk_bf16_f32 v56, v56, v57
  v_cvt_pk_bf16_f32 v57, v58, v59
  v_cvt_pk_bf16_f32 v58, v60, v61
  v_cvt_pk_bf16_f32 v59, v62, v63
  buffer_store_dwordx4 v[56:59], v7, s[20:23], s41 offen offset:1280 sc1
  v_pk_mul_f32 v[72:73], v[72:73], v[80:81]
  v_pk_mul_f32 v[74:75], v[74:75], v[82:83]
  v_pk_mul_f32 v[76:77], v[76:77], v[84:85]
  v_pk_mul_f32 v[78:79], v[78:79], v[86:87]
  v_pk_fma_f32 v[72:73], v[88:89], v[14:15], v[72:73] op_sel_hi:[1,0,1]
  v_pk_fma_f32 v[74:75], v[90:91], v[14:15], v[74:75] op_sel_hi:[1,0,1]
  v_pk_fma_f32 v[76:77], v[92:93], v[14:15], v[76:77] op_sel_hi:[1,0,1]
  v_pk_fma_f32 v[78:79], v[94:95], v[14:15], v[78:79] op_sel_hi:[1,0,1]
  v_cvt_pk_bf16_f32 v72, v72, v73
  v_cvt_pk_bf16_f32 v73, v74, v75
  v_cvt_pk_bf16_f32 v74, v76, v77
  v_cvt_pk_bf16_f32 v75, v78, v79
  buffer_store_dwordx4 v[72:75], v8, s[20:23], s41 offen offset:1280 sc1
  s_nop 1
LJ_2:
  v_mfma_f32_32x32x16_bf16 v[48:63], v[32:35], v[96:99], 0
  ds_read_b64_tr_b16 v[32:33], v11 offset:6144
  ds_read_b64_tr_b16 v[34:35], v11 offset:6912
  buffer_load_dwordx4 v6, s[12:15], s78 offen offset:2048 lds
  s_add_u32 s92, s92, 1
  s_cmp_eq_u32 s92, 10
  s_cselect_b32 s92, 0, s92
  v_mfma_f32_32x32x16_bf16 v[64:79], v[36:39], v[96:99], 0
  ds_read_b64_tr_b16 v[36:37], v12 offset:6144
  ds_read_b64_tr_b16 v[38:39], v12 offset:6912
  v_mfma_f32_32x32x16_bf16 v[80:95], v[40:43], v[96:99], 0
  ds_read_b64_tr_b16 v[40:41], v13 offset:6144
  ds_read_b64_tr_b16 v[42:43], v13 offset:6912
  v_mfma_f32_32x32x16_bf16 v[48:63], v[44:47], v[100:103], v[48:63]
  ds_read_b64_tr_b16 v[44:45], v11 offset:9216
  ds_read_b64_tr_b16 v[46:47], v11 offset:9984
  v_mfma_f32_32x32x16_bf16 v[64:79], v[24:27], v[100:103], v[64:79]
  ds_read_b64_tr_b16 v[24:25], v12 offset:9216
  ds_read_b64_tr_b16 v[26:27], v12 offset:9984
  v_mov_b32 v96, -1
  v_mov_b32 v97, -1
  v_mov_b32 v98, -1
  v_mov_b32 v99, -1
  s_lshl_b32 s41, s32, 3
  s_lshr_b32 s42, s33, 1
  s_add_u32 s41, s41, s42
  s_mul_i32 s41, s41, 69632
  s_and_b32 s42, s33, 1
  s_lshl_b32 s42, s42, 3
  s_add_u32 s42, s42, s34
  s_mul_i32 s42, s42, 1280
  s_add_u32 s41, s41, s42
  s_add_u32 s41, s41, 7913472
  v_lshlrev_b32 v19, 4, v0
  v_lshlrev_b32 v22, 2, v0
  buffer_store_dwordx4 v[96:99], v19, s[20:23], s41 offen sc1
  buffer_store_dword v96, v22, s[20:23], s41 offen offset:1024 sc1
  v_mfma_f32_32x32x16_bf16 v[80:95], v[28:31], v[100:103], v[80:95]
  ds_read_b64_tr_b16 v[28:29], v13 offset:9216
  ds_read_b64_tr_b16 v[30:31], v13 offset:9984
  s_waitcnt lgkmcnt(10)
  v_mfma_f32_32x32x16_bf16 v[48:63], v[32:35], v[104:107], v[48:63]
  s_waitcnt vmcnt(12)
  s_barrier
  ds_read_b64_tr_b16 v[32:33], v11 offset:24576
  ds_read_b64_tr_b16 v[34:35], v11 offset:25344
  s_add_u32 m0, s47, 65536
  s_mul_i32 s78, s92, 196608
  buffer_load_dwordx4 v4, s[12:15], s78 offen lds
  s_waitcnt lgkmcnt(10)
  v_mfma_f32_32x32x16_bf16 v[64:79], v[36:39], v[104:107], v[64:79]
  ds_read_b64_tr_b16 v[36:37], v12 offset:24576
  ds_read_b64_tr_b16 v[38:39], v12 offset:25344
  v_lshrrev_b32 v19, 4, v0
  v_bfe_u32 v22, v0, 2, 2
  v_lshl_add_u32 v19, v19, 3, v22
  s_waitcnt lgkmcnt(10)
  v_mfma_f32_32x32x16_bf16 v[80:95], v[40:43], v[104:107], v[80:95]
  ds_read_b64_tr_b16 v[40:41], v13 offset:24576
  ds_read_b64_tr_b16 v[42:43], v13 offset:25344
  v_and_b32 v22, 3, v0
  v_lshlrev_b32 v22, 3, v22
  v_lshl_add_u32 v19, v19, 8, v22
  s_waitcnt lgkmcnt(10)
  v_mfma_f32_32x32x16_bf16 v[48:63], v[44:47], v[108:111], v[48:63]
  ds_read_b64_tr_b16 v[44:45], v11 offset:27648
  ds_read_b64_tr_b16 v[46:47], v11 offset:28416
  buffer_load_dwordx4 v5, s[12:15], s78 offen offset:1024 lds
  s_lshl_b32 s38, s34, 5
  v_add_u32 v19, s38, v19
  ds_read_b64_tr_b16 v[96:97], v19 offset:16384
  ds_read_b64_tr_b16 v[98:99], v19 offset:17408
  v_lshl_add_u32 v22, v0, 4, s68
  s_waitcnt lgkmcnt(12)
  v_mfma_f32_32x32x16_bf16 v[64:79], v[24:27], v[108:111], v[64:79]
  ds_read_b64_tr_b16 v[24:25], v12 offset:27648
  ds_read_b64_tr_b16 v[26:27], v12 offset:28416
  s_waitcnt lgkmcnt(12)
  v_mfma_f32_32x32x16_bf16 v[80:95], v[28:31], v[108:111], v[80:95]
  ds_read_b64_tr_b16 v[28:29], v13 offset:27648
  ds_read_b64_tr_b16 v[30:31], v13 offset:28416
  s_waitcnt lgkmcnt(4)
  buffer_store_dwordx4 v[96:99], v22, s[20:23], 0 offen sc1
  v_mfma_f32_32x32x16_bf16 v[48:63], v[32:35], v[112:115], v[48:63]
  ds_read_b64_tr_b16 v[32:33], v11 offset:30720
  ds_read_b64_tr_b16 v[34:35], v11 offset:31488
  buffer_load_dwordx4 v6, s[12:15], s78 offen offset:2048 lds
  s_add_u32 s92, s92, 1
  s_cmp_eq_u32 s92, 10
  s_cselect_b32 s92, 0, s92
  v_mfma_f32_32x32x16_bf16 v[64:79], v[36:39], v[112:115], v[64:79]
  ds_read_b64_tr_b16 v[36:37], v12 offset:30720
  ds_read_b64_tr_b16 v[38:39], v12 offset:31488
  v_mfma_f32_32x32x16_bf16 v[80:95], v[40:43], v[112:115], v[80:95]
  ds_read_b64_tr_b16 v[40:41], v13 offset:30720
  ds_read_b64_tr_b16 v[42:43], v13 offset:31488
  v_mfma_f32_32x32x16_bf16 v[48:63], v[44:47], v[116:119], v[48:63]
  ds_read_b64_tr_b16 v[44:45], v11 offset:33792
  ds_read_b64_tr_b16 v[46:47], v11 offset:34560
  s_waitcnt lgkmcnt(10)
  v_mfma_f32_32x32x16_bf16 v[64:79], v[24:27], v[116:119], v[64:79]
  ds_read_b64_tr_b16 v[24:25], v12 offset:33792
  ds_read_b64_tr_b16 v[26:27], v12 offset:34560
  s_waitcnt lgkmcnt(10)
  v_mfma_f32_32x32x16_bf16 v[80:95], v[28:31], v[116:119], v[80:95]
  ds_read_b64_tr_b16 v[28:29], v13 offset:33792
  ds_read_b64_tr_b16 v[30:31], v13 offset:34560
  s_waitcnt lgkmcnt(10)
  v_mfma_f32_32x32x16_bf16 v[48:63], v[32:35], v[120:123], v[48:63]
  s_waitcnt vmcnt(13)
  s_barrier
  v_add_u32 v11, 49152, v11
  ds_read_b64_tr_b16 v[32:33], v11 offset:0
  ds_read_b64_tr_b16 v[34:35], v11 offset:768
  s_add_u32 m0, s47, 90112
  s_mul_i32 s78, s92, 196608
  buffer_load_dwordx4 v4, s[12:15], s78 offen lds
  s_waitcnt lgkmcnt(10)
  v_mfma_f32_32x32x16_bf16 v[64:79], v[36:39], v[120:123], v[64:79]
  v_add_u32 v12, 49152, v12
  ds_read_b64_tr_b16 v[36:37], v12 offset:0
  ds_read_b64_tr_b16 v[38:39], v12 offset:768
  s_waitcnt lgkmcnt(10)
  v_mfma_f32_32x32x16_bf16 v[80:95], v[40:43], v[120:123], v[80:95]
  v_add_u32 v13, 49152, v13
  ds_read_b64_tr_b16 v[40:41], v13 offset:0
  ds_read_b64_tr_b16 v[42:43], v13 offset:768
  s_waitcnt lgkmcnt(10)
  v_mfma_f32_32x32x16_bf16 v[48:63], v[44:47], v[124:127], v[48:63]
  ds_read_b64_tr_b16 v[44:45], v11 offset:3072
  ds_read_b64_tr_b16 v[46:47], v11 offset:3840
  buffer_load_dwordx4 v5, s[12:15], s78 offen offset:1024 lds
  s_cmp_eq_u32 s94, 1
  s_cselect_b64 vcc, -1, 0
  v_cndmask_b32 v7, v11, v12, vcc
  s_cmp_eq_u32 s94, 2
  s_cselect_b64 vcc, -1, 0
  v_cndmask_b32 v7, v7, v13, vcc
  s_mul_i32 s38, s35, 3072
  v_add_u32 v7, s38, v7
  s_waitcnt lgkmcnt(10)
  v_mfma_f32_32x32x16_bf16 v[64:79], v[24:27], v[124:127], v[64:79]
  ds_read_b64_tr_b16 v[24:25], v12 offset:3072
  ds_read_b64_tr_b16 v[26:27], v12 offset:3840
  ds_read_b64_tr_b16 v[112:113], v7 offset:0
  ds_read_b64_tr_b16 v[114:115], v7 offset:768
  s_waitcnt lgkmcnt(12)
  v_mfma_f32_32x32x16_bf16 v[80:95], v[28:31], v[124:127], v[80:95]
  ds_read_b64_tr_b16 v[28:29], v13 offset:3072
  ds_read_b64_tr_b16 v[30:31], v13 offset:3840
  v_mov_b32 v120, s37
  v_mov_b32 v121, s37
  v_mov_b32 v122, s37
  v_mov_b32 v123, s37
  s_waitcnt lgkmcnt(12)
  v_mfma_f32_32x32x16_bf16 v[48:63], v[32:35], v[128:131], v[48:63]
  ds_read_b64_tr_b16 v[32:33], v11 offset:6144
  ds_read_b64_tr_b16 v[34:35], v11 offset:6912
  buffer_load_dwordx4 v6, s[12:15], s78 offen offset:2048 lds
  s_add_u32 s92, s92, 1
  s_cmp_eq_u32 s92, 10
  s_cselect_b32 s92, 0, s92
  s_waitcnt lgkmcnt(12)
  v_mfma_f32_32x32x16_bf16 v[64:79], v[36:39], v[128:131], v[64:79]
  ds_read_b64_tr_b16 v[36:37], v12 offset:6144
  ds_read_b64_tr_b16 v[38:39], v12 offset:6912
  s_waitcnt lgkmcnt(12)
  v_mfma_f32_32x32x16_bf16 v[80:95], v[40:43], v[128:131], v[80:95]
  ds_read_b64_tr_b16 v[40:41], v13 offset:6144
  ds_read_b64_tr_b16 v[42:43], v13 offset:6912
  s_waitcnt lgkmcnt(8)
  v_mfma_f32_32x32x16_bf16 v[96:111], v[120:123], v[112:115], 0
  v_mfma_f32_32x32x16_bf16 v[48:63], v[44:47], v[132:135], v[48:63]
  ds_read_b64_tr_b16 v[44:45], v11 offset:9216
  ds_read_b64_tr_b16 v[46:47], v11 offset:9984
  v_mfma_f32_32x32x16_bf16 v[64:79], v[24:27], v[132:135], v[64:79]
  ds_read_b64_tr_b16 v[24:25], v12 offset:9216
  ds_read_b64_tr_b16 v[26:27], v12 offset:9984
  s_waitcnt lgkmcnt(10)
  v_mfma_f32_32x32x16_bf16 v[80:95], v[28:31], v[132:135], v[80:95]
  ds_read_b64_tr_b16 v[28:29], v13 offset:9216
  ds_read_b64_tr_b16 v[30:31], v13 offset:9984
  s_waitcnt lgkmcnt(10)
  v_mfma_f32_32x32x16_bf16 v[48:63], v[32:35], v[136:139], v[48:63]
  s_waitcnt vmcnt(9)
  s_waitcnt vmcnt(4)
  s_barrier
  v_lshl_add_u32 v19, v0, 2, s79
  s_add_u32 s38, s3, 1
  v_mov_b32 v22, s38
  buffer_store_dword v22, v19, s[20:23], 0 offen sc1
  ds_read_b64_tr_b16 v[32:33], v11 offset:24576
  ds_read_b64_tr_b16 v[34:35], v11 offset:25344
  s_add_u32 m0, s47, 114688
  s_mul_i32 s78, s92, 196608
  buffer_load_dwordx4 v4, s[12:15], s78 offen lds
  ds_read_b64_tr_b16 v[116:117], v7 offset:24576
  ds_read_b64_tr_b16 v[118:119], v7 offset:25344
  s_waitcnt lgkmcnt(12)
  v_mfma_f32_32x32x16_bf16 v[64:79], v[36:39], v[136:139], v[64:79]
  ds_read_b64_tr_b16 v[36:37], v12 offset:24576
  ds_read_b64_tr_b16 v[38:39], v12 offset:25344
  s_waitcnt lgkmcnt(12)
  v_mfma_f32_32x32x16_bf16 v[80:95], v[40:43], v[136:139], v[80:95]
  ds_read_b64_tr_b16 v[40:41], v13 offset:24576
  ds_read_b64_tr_b16 v[42:43], v13 offset:25344
  s_waitcnt lgkmcnt(12)
  v_mfma_f32_32x32x16_bf16 v[48:63], v[44:47], v[140:143], v[48:63]
  ds_read_b64_tr_b16 v[44:45], v11 offset:27648
  ds_read_b64_tr_b16 v[46:47], v11 offset:28416
  buffer_load_dwordx4 v5, s[12:15], s78 offen offset:1024 lds
  s_waitcnt lgkmcnt(12)
  v_mfma_f32_32x32x16_bf16 v[64:79], v[24:27], v[140:143], v[64:79]
  ds_read_b64_tr_b16 v[24:25], v12 offset:27648
  ds_read_b64_tr_b16 v[26:27], v12 offset:28416
  s_waitcnt lgkmcnt(8)
  v_mfma_f32_32x32x16_bf16 v[96:111], v[120:123], v[116:119], v[96:111]
  v_mfma_f32_32x32x16_bf16 v[80:95], v[28:31], v[140:143], v[80:95]
  ds_read_b64_tr_b16 v[28:29], v13 offset:27648
  ds_read_b64_tr_b16 v[30:31], v13 offset:28416
  v_and_b32 v7, 3, v0
  v_bfe_u32 v112, v0, 2, 1
  v_lshl_add_u32 v7, v112, 4, v7
  v_bfe_u32 v112, v0, 3, 2
  v_lshl_add_u32 v7, v112, 2, v7
  v_mfma_f32_32x32x16_bf16 v[48:63], v[32:35], v[144:147], v[48:63]
  ds_read_b64_tr_b16 v[32:33], v11 offset:30720
  ds_read_b64_tr_b16 v[34:35], v11 offset:31488
  buffer_load_dwordx4 v6, s[12:15], s78 offen offset:2048 lds
  s_add_u32 s92, s92, 1
  s_cmp_eq_u32 s92, 10
  s_cselect_b32 s92, 0, s92
  s_waitcnt lgkmcnt(10)
  v_mfma_f32_32x32x16_bf16 v[64:79], v[36:39], v[144:147], v[64:79]
  ds_read_b64_tr_b16 v[36:37], v12 offset:30720
  ds_read_b64_tr_b16 v[38:39], v12 offset:31488
  s_waitcnt lgkmcnt(10)
  v_mfma_f32_32x32x16_bf16 v[80:95], v[40:43], v[144:147], v[80:95]
  ds_read_b64_tr_b16 v[40:41], v13 offset:30720
  ds_read_b64_tr_b16 v[42:43], v13 offset:31488
  s_lshl_b32 s38, s35, 8
  s_lshl_b32 s39, s36, 7
  s_add_u32 s38, s38, s39
  v_lshl_add_u32 v7, v7, 2, s38
  ds_write_b32 v7, v96 offset:4096
  v_lshlrev_b32 v112, 2, v0
  s_waitcnt lgkmcnt(11)
  v_mfma_f32_32x32x16_bf16 v[48:63], v[44:47], v[148:151], v[48:63]
  ds_read_b64_tr_b16 v[44:45], v11 offset:33792
  ds_read_b64_tr_b16 v[46:47], v11 offset:34560
  s_waitcnt lgkmcnt(11)
  v_mfma_f32_32x32x16_bf16 v[64:79], v[24:27], v[148:151], v[64:79]
  ds_read_b64_tr_b16 v[24:25], v12 offset:33792
  ds_read_b64_tr_b16 v[26:27], v12 offset:34560
  s_waitcnt lgkmcnt(11)
  v_mfma_f32_32x32x16_bf16 v[80:95], v[28:31], v[148:151], v[80:95]
  ds_read_b64_tr_b16 v[28:29], v13 offset:33792
  ds_read_b64_tr_b16 v[30:31], v13 offset:34560
  s_waitcnt lgkmcnt(11)
  v_mfma_f32_32x32x16_bf16 v[48:63], v[32:35], v[152:155], v[48:63]
  s_waitcnt vmcnt(7)
  s_waitcnt lgkmcnt(6)
  s_barrier
  v_subrev_u32 v11, 49152, v11
  ds_read_b64_tr_b16 v[32:33], v11 offset:0
  ds_read_b64_tr_b16 v[34:35], v11 offset:768
  s_add_u32 m0, s47, 139264
  s_mul_i32 s78, s92, 196608
  buffer_load_dwordx4 v4, s[12:15], s78 offen lds
  ds_read2st64_b32 v[120:121], v112 offset0:16 offset1:17
  ds_read2st64_b32 v[122:123], v112 offset0:18 offset1:19
  v_lshrrev_b32 v7, 5, v0
  v_lshlrev_b32 v7, 9, v7
  v_lshl_add_u32 v7, v0, 3, v7
  v_mfma_f32_32x32x16_bf16 v[64:79], v[36:39], v[152:155], v[64:79]
  v_subrev_u32 v12, 49152, v12
  ds_read_b64_tr_b16 v[36:37], v12 offset:0
  ds_read_b64_tr_b16 v[38:39], v12 offset:768
  v_mfma_f32_32x32x16_bf16 v[80:95], v[40:43], v[152:155], v[80:95]
  v_subrev_u32 v13, 49152, v13
  ds_read_b64_tr_b16 v[40:41], v13 offset:0
  ds_read_b64_tr_b16 v[42:43], v13 offset:768
  s_waitcnt lgkmcnt(12)
  v_mfma_f32_32x32x16_bf16 v[48:63], v[44:47], v[156:159], v[48:63]
  ds_read_b64_tr_b16 v[44:45], v11 offset:3072
  ds_read_b64_tr_b16 v[46:47], v11 offset:3840
  buffer_load_dwordx4 v5, s[12:15], s78 offen offset:1024 lds
  s_waitcnt lgkmcnt(12)
  v_mfma_f32_32x32x16_bf16 v[64:79], v[24:27], v[156:159], v[64:79]
  ds_read_b64_tr_b16 v[24:25], v12 offset:3072
  ds_read_b64_tr_b16 v[26:27], v12 offset:3840
  s_cmp_lt_u32 s94, 3
  s_cselect_b32 s38, s93, 117440512
  v_add_u32 v7, s38, v7
  s_waitcnt lgkmcnt(8)
  v_add_f32 v120, v120, v121
  v_add_f32 v122, v122, v123
  v_mov_b32 v121, s3
  v_add_f32 v120, v120, v122
  buffer_store_dwordx2 v[120:121], v7, s[20:23], 0 offen offset:1024 sc1
  v_mfma_f32_32x32x16_bf16 v[80:95], v[28:31], v[156:159], v[80:95]
  ds_read_b64_tr_b16 v[28:29], v13 offset:3072
  ds_read_b64_tr_b16 v[30:31], v13 offset:3840
  v_mfma_f32_32x32x16_bf16 v[48:63], v[32:35], v[160:163], v[48:63]
  ds_read_b64_tr_b16 v[32:33], v11 offset:6144
  ds_read_b64_tr_b16 v[34:35], v11 offset:6912
  buffer_load_dwordx4 v6, s[12:15], s78 offen offset:2048 lds
  s_add_u32 s92, s92, 1
  s_cmp_eq_u32 s92, 10
  s_cselect_b32 s92, 0, s92
  s_waitcnt lgkmcnt(10)
  v_mfma_f32_32x32x16_bf16 v[64:79], v[36:39], v[160:163], v[64:79]
  ds_read_b64_tr_b16 v[36:37], v12 offset:6144
  ds_read_b64_tr_b16 v[38:39], v12 offset:6912
  s_waitcnt lgkmcnt(10)
  v_mfma_f32_32x32x16_bf16 v[80:95], v[40:43], v[160:163], v[80:95]
  ds_read_b64_tr_b16 v[40:41], v13 offset:6144
  ds_read_b64_tr_b16 v[42:43], v13 offset:6912
  s_waitcnt lgkmcnt(10)
  v_mfma_f32_32x32x16_bf16 v[48:63], v[44:47], v[164:167], v[48:63]
  ds_read_b64_tr_b16 v[44:45], v11 offset:9216
  ds_read_b64_tr_b16 v[46:47], v11 offset:9984
  s_waitcnt lgkmcnt(10)
  v_mfma_f32_32x32x16_bf16 v[64:79], v[24:27], v[164:167], v[64:79]
  ds_read_b64_tr_b16 v[24:25], v12 offset:9216
  ds_read_b64_tr_b16 v[26:27], v12 offset:9984
  s_waitcnt lgkmcnt(10)
  v_mfma_f32_32x32x16_bf16 v[80:95], v[28:31], v[164:167], v[80:95]
  ds_read_b64_tr_b16 v[28:29], v13 offset:9216
  ds_read_b64_tr_b16 v[30:31], v13 offset:9984
  s_waitcnt lgkmcnt(10)
  v_mfma_f32_32x32x16_bf16 v[48:63], v[32:35], v[168:171], v[48:63]
  s_waitcnt vmcnt(8)
  s_barrier
  ds_read_b64_tr_b16 v[32:33], v11 offset:24576
  ds_read_b64_tr_b16 v[34:35], v11 offset:25344
  s_add_u32 m0, s47, 65536
  s_mul_i32 s78, s92, 196608
  buffer_load_dwordx4 v4, s[12:15], s78 offen lds
  s_waitcnt lgkmcnt(10)
  v_mfma_f32_32x32x16_bf16 v[64:79], v[36:39], v[168:171], v[64:79]
  ds_read_b64_tr_b16 v[36:37], v12 offset:24576
  ds_read_b64_tr_b16 v[38:39], v12 offset:25344
  s_waitcnt lgkmcnt(10)
  v_mfma_f32_32x32x16_bf16 v[80:95], v[40:43], v[168:171], v[80:95]
  ds_read_b64_tr_b16 v[40:41], v13 offset:24576
  ds_read_b64_tr_b16 v[42:43], v13 offset:25344
  s_waitcnt lgkmcnt(10)
  v_mfma_f32_32x32x16_bf16 v[48:63], v[44:47], v[172:175], v[48:63]
  ds_read_b64_tr_b16 v[44:45], v11 offset:27648
  ds_read_b64_tr_b16 v[46:47], v11 offset:28416
  buffer_load_dwordx4 v5, s[12:15], s78 offen offset:1024 lds
  s_waitcnt lgkmcnt(10)
  v_mfma_f32_32x32x16_bf16 v[64:79], v[24:27], v[172:175], v[64:79]
  ds_read_b64_tr_b16 v[24:25], v12 offset:27648
  ds_read_b64_tr_b16 v[26:27], v12 offset:28416
  s_waitcnt lgkmcnt(10)
  v_mfma_f32_32x32x16_bf16 v[80:95], v[28:31], v[172:175], v[80:95]
  ds_read_b64_tr_b16 v[28:29], v13 offset:27648
  ds_read_b64_tr_b16 v[30:31], v13 offset:28416
  s_waitcnt lgkmcnt(10)
  v_mfma_f32_32x32x16_bf16 v[48:63], v[32:35], v[176:179], v[48:63]
  ds_read_b64_tr_b16 v[32:33], v11 offset:30720
  ds_read_b64_tr_b16 v[34:35], v11 offset:31488
  buffer_load_dwordx4 v6, s[12:15], s78 offen offset:2048 lds
  s_add_u32 s92, s92, 1
  s_cmp_eq_u32 s92, 10
  s_cselect_b32 s92, 0, s92
  s_waitcnt lgkmcnt(10)
  v_mfma_f32_32x32x16_bf16 v[64:79], v[36:39], v[176:179], v[64:79]
  ds_read_b64_tr_b16 v[36:37], v12 offset:30720
  ds_read_b64_tr_b16 v[38:39], v12 offset:31488
  s_waitcnt lgkmcnt(10)
  v_mfma_f32_32x32x16_bf16 v[80:95], v[40:43], v[176:179], v[80:95]
  ds_read_b64_tr_b16 v[40:41], v13 offset:30720
  ds_read_b64_tr_b16 v[42:43], v13 offset:31488
  s_waitcnt lgkmcnt(10)
  v_mfma_f32_32x32x16_bf16 v[48:63], v[44:47], v[180:183], v[48:63]
  ds_read_b64_tr_b16 v[44:45], v11 offset:33792
  ds_read_b64_tr_b16 v[46:47], v11 offset:34560
  s_waitcnt lgkmcnt(10)
  v_mfma_f32_32x32x16_bf16 v[64:79], v[24:27], v[180:183], v[64:79]
  ds_read_b64_tr_b16 v[24:25], v12 offset:33792
  ds_read_b64_tr_b16 v[26:27], v12 offset:34560
  s_waitcnt lgkmcnt(10)
  v_mfma_f32_32x32x16_bf16 v[80:95], v[28:31], v[180:183], v[80:95]
  ds_read_b64_tr_b16 v[28:29], v13 offset:33792
  ds_read_b64_tr_b16 v[30:31], v13 offset:34560
  s_waitcnt lgkmcnt(10)
  v_mfma_f32_32x32x16_bf16 v[48:63], v[32:35], v[184:187], v[48:63]
  s_waitcnt vmcnt(7)
  s_barrier
  v_add_u32 v11, 49152, v11
  ds_read_b64_tr_b16 v[32:33], v11 offset:0
  ds_read_b64_tr_b16 v[34:35], v11 offset:768
  s_add_u32 m0, s47, 90112
  s_mul_i32 s78, s92, 196608
  buffer_load_dwordx4 v4, s[12:15], s78 offen lds
  s_waitcnt lgkmcnt(10)
  v_mfma_f32_32x32x16_bf16 v[64:79], v[36:39], v[184:187], v[64:79]
  v_add_u32 v12, 49152, v12
  ds_read_b64_tr_b16 v[36:37], v12 offset:0
  ds_read_b64_tr_b16 v[38:39], v12 offset:768
  s_waitcnt lgkmcnt(10)
  v_mfma_f32_32x32x16_bf16 v[80:95], v[40:43], v[184:187], v[80:95]
  v_add_u32 v13, 49152, v13
  ds_read_b64_tr_b16 v[40:41], v13 offset:0
  ds_read_b64_tr_b16 v[42:43], v13 offset:768
  s_waitcnt lgkmcnt(10)
  v_mfma_f32_32x32x16_bf16 v[48:63], v[44:47], v[188:191], v[48:63]
  ds_read_b64_tr_b16 v[44:45], v11 offset:3072
  ds_read_b64_tr_b16 v[46:47], v11 offset:3840
  buffer_load_dwordx4 v5, s[12:15], s78 offen offset:1024 lds
  s_waitcnt lgkmcnt(10)
  v_mfma_f32_32x32x16_bf16 v[64:79], v[24:27], v[188:191], v[64:79]
  ds_read_b64_tr_b16 v[24:25], v12 offset:3072
  ds_read_b64_tr_b16 v[26:27], v12 offset:3840
  s_waitcnt lgkmcnt(10)
  v_mfma_f32_32x32x16_bf16 v[80:95], v[28:31], v[188:191], v[80:95]
  ds_read_b64_tr_b16 v[28:29], v13 offset:3072
  ds_read_b64_tr_b16 v[30:31], v13 offset:3840
  s_waitcnt lgkmcnt(10)
  v_mfma_f32_32x32x16_bf16 v[48:63], v[32:35], v[192:195], v[48:63]
  ds_read_b64_tr_b16 v[32:33], v11 offset:6144
  ds_read_b64_tr_b16 v[34:35], v11 offset:6912
  buffer_load_dwordx4 v6, s[12:15], s78 offen offset:2048 lds
  s_add_u32 s92, s92, 1
  s_cmp_eq_u32 s92, 10
  s_cselect_b32 s92, 0, s92
  s_waitcnt lgkmcnt(10)
  v_mfma_f32_32x32x16_bf16 v[64:79], v[36:39], v[192:195], v[64:79]
  ds_read_b64_tr_b16 v[36:37], v12 offset:6144
  ds_read_b64_tr_b16 v[38:39], v12 offset:6912
  v_lshlrev_b32 v3, 4, v0
  s_lshl_b32 s38, s34, 13
  s_add_u32 s38, s38, 21364736
  v_and_b32 v185, 31, v0
  v_lshl_add_u32 v185, v185, 8, s38
  buffer_load_dword v184, v185, s[20:23], 0 offen sc1
  s_mul_i32 s69, s33, 327680
  s_add_u32 s69, s69, 2621440
  s_mul_i32 s70, s32, 20480
  s_sub_i32 s70, s70, 40960
  s_waitcnt lgkmcnt(10)
  v_mfma_f32_32x32x16_bf16 v[80:95], v[40:43], v[192:195], v[80:95]
  ds_read_b64_tr_b16 v[40:41], v13 offset:6144
  ds_read_b64_tr_b16 v[42:43], v13 offset:6912
  s_waitcnt lgkmcnt(10)
  v_mfma_f32_32x32x16_bf16 v[48:63], v[44:47], v[196:199], v[48:63]
  ds_read_b64_tr_b16 v[44:45], v11 offset:9216
  ds_read_b64_tr_b16 v[46:47], v11 offset:9984
  s_waitcnt lgkmcnt(10)
  v_mfma_f32_32x32x16_bf16 v[64:79], v[24:27], v[196:199], v[64:79]
  ds_read_b64_tr_b16 v[24:25], v12 offset:9216
  ds_read_b64_tr_b16 v[26:27], v12 offset:9984
  s_waitcnt lgkmcnt(10)
  v_mfma_f32_32x32x16_bf16 v[80:95], v[28:31], v[196:199], v[80:95]
  ds_read_b64_tr_b16 v[28:29], v13 offset:9216
  ds_read_b64_tr_b16 v[30:31], v13 offset:9984
  s_waitcnt lgkmcnt(10)
  v_mfma_f32_32x32x16_bf16 v[48:63], v[32:35], v[200:203], v[48:63]
  s_waitcnt vmcnt(7)
  s_barrier
  ds_read_b64_tr_b16 v[32:33], v11 offset:24576
  ds_read_b64_tr_b16 v[34:35], v11 offset:25344
  s_waitcnt lgkmcnt(10)
  v_mfma_f32_32x32x16_bf16 v[64:79], v[36:39], v[200:203], v[64:79]
  ds_read_b64_tr_b16 v[36:37], v12 offset:24576
  ds_read_b64_tr_b16 v[38:39], v12 offset:25344
  s_waitcnt lgkmcnt(10)
  v_mfma_f32_32x32x16_bf16 v[80:95], v[40:43], v[200:203], v[80:95]
  ds_read_b64_tr_b16 v[40:41], v13 offset:24576
  ds_read_b64_tr_b16 v[42:43], v13 offset:25344
  s_waitcnt lgkmcnt(10)
  v_mfma_f32_32x32x16_bf16 v[48:63], v[44:47], v[204:207], v[48:63]
  ds_read_b64_tr_b16 v[44:45], v11 offset:27648
  ds_read_b64_tr_b16 v[46:47], v11 offset:28416
  s_waitcnt lgkmcnt(10)
  v_mfma_f32_32x32x16_bf16 v[64:79], v[24:27], v[204:207], v[64:79]
  ds_read_b64_tr_b16 v[24:25], v12 offset:27648
  ds_read_b64_tr_b16 v[26:27], v12 offset:28416
  s_waitcnt lgkmcnt(10)
  v_mfma_f32_32x32x16_bf16 v[80:95], v[28:31], v[204:207], v[80:95]
  ds_read_b64_tr_b16 v[28:29], v13 offset:27648
  ds_read_b64_tr_b16 v[30:31], v13 offset:28416
  s_waitcnt lgkmcnt(10)
  v_mfma_f32_32x32x16_bf16 v[48:63], v[32:35], v[208:211], v[48:63]
  ds_read_b64_tr_b16 v[32:33], v11 offset:30720
  ds_read_b64_tr_b16 v[34:35], v11 offset:31488
  s_waitcnt lgkmcnt(10)
  v_mfma_f32_32x32x16_bf16 v[64:79], v[36:39], v[208:211], v[64:79]
  ds_read_b64_tr_b16 v[36:37], v12 offset:30720
  ds_read_b64_tr_b16 v[38:39], v12 offset:31488
  s_waitcnt lgkmcnt(10)
  v_mfma_f32_32x32x16_bf16 v[80:95], v[40:43], v[208:211], v[80:95]
  ds_read_b64_tr_b16 v[40:41], v13 offset:30720
  ds_read_b64_tr_b16 v[42:43], v13 offset:31488
  s_waitcnt lgkmcnt(10)
  v_mfma_f32_32x32x16_bf16 v[48:63], v[44:47], v[212:215], v[48:63]
  ds_read_b64_tr_b16 v[44:45], v11 offset:33792
  ds_read_b64_tr_b16 v[46:47], v11 offset:34560
  s_waitcnt lgkmcnt(10)
  v_mfma_f32_32x32x16_bf16 v[64:79], v[24:27], v[212:215], v[64:79]
  ds_read_b64_tr_b16 v[24:25], v12 offset:33792
  ds_read_b64_tr_b16 v[26:27], v12 offset:34560
  s_waitcnt lgkmcnt(10)
  v_mfma_f32_32x32x16_bf16 v[80:95], v[28:31], v[212:215], v[80:95]
  ds_read_b64_tr_b16 v[28:29], v13 offset:33792
  ds_read_b64_tr_b16 v[30:31], v13 offset:34560
  s_waitcnt vmcnt(0)
  v_subrev_u32 v184, s3, v184
  v_subrev_u32 v184, 1, v184
  v_cmp_lt_u32 vcc, 2, v184
  s_cbranch_vccnz SP_13
RT_14:
  s_waitcnt lgkmcnt(10)
  v_mfma_f32_32x32x16_bf16 v[48:63], v[32:35], v[216:219], v[48:63]
  s_barrier
  s_or_b32 s38, s2, s34
  s_cselect_b32 s38, 117440512, 0
  s_add_u32 s38, s38, 21495808
  v_lshl_add_u32 v186, v0, 2, s38
  v_mov_b32 v187, s3
  buffer_store_dword v187, v186, s[20:23], 0 offen sc1
  v_subrev_u32 v11, 49152, v11
  ds_read_b64_tr_b16 v[32:33], v11 offset:0
  ds_read_b64_tr_b16 v[34:35], v11 offset:768
  s_add_u32 s38, s34, 0
  s_lshl_b32 s38, s38, 10
  s_add_i32 s38, s38, s70
  s_max_i32 s38, s38, 0
  s_add_u32 s38, s38, s69
  buffer_load_dwordx4 v[144:147], v3, s[20:23], s38 offen sc1
  s_waitcnt lgkmcnt(10)
  v_mfma_f32_32x32x16_bf16 v[64:79], v[36:39], v[216:219], v[64:79]
  v_subrev_u32 v12, 49152, v12
  ds_read_b64_tr_b16 v[36:37], v12 offset:0
  ds_read_b64_tr_b16 v[38:39], v12 offset:768
  s_add_u32 s38, s34, 8
  s_lshl_b32 s38, s38, 10
  s_add_i32 s38, s38, s70
  s_max_i32 s38, s38, 0
  s_add_u32 s38, s38, s69
  buffer_load_dwordx4 v[148:151], v3, s[20:23], s38 offen sc1
  s_waitcnt lgkmcnt(10)
  v_mfma_f32_32x32x16_bf16 v[80:95], v[40:43], v[216:219], v[80:95]
  v_subrev_u32 v13, 49152, v13
  ds_read_b64_tr_b16 v[40:41], v13 offset:0
  ds_read_b64_tr_b16 v[42:43], v13 offset:768
  s_add_u32 s38, s34, 16
  s_lshl_b32 s38, s38, 10
  s_add_i32 s38, s38, s70
  s_max_i32 s38, s38, 0
  s_add_u32 s38, s38, s69
  buffer_load_dwordx4 v[152:155], v3, s[20:23], s38 offen sc1
  s_waitcnt lgkmcnt(10)
  v_mfma_f32_32x32x16_bf16 v[48:63], v[44:47], v[220:223], v[48:63]
  ds_read_b64_tr_b16 v[44:45], v11 offset:3072
  ds_read_b64_tr_b16 v[46:47], v11 offset:3840
  s_add_u32 s38, s34, 24
  s_lshl_b32 s38, s38, 10
  s_add_i32 s38, s38, s70
  s_max_i32 s38, s38, 0
  s_add_u32 s38, s38, s69
  buffer_load_dwordx4 v[156:159], v3, s[20:23], s38 offen sc1
  s_waitcnt lgkmcnt(10)
  v_mfma_f32_32x32x16_bf16 v[64:79], v[24:27], v[220:223], v[64:79]
  ds_read_b64_tr_b16 v[24:25], v12 offset:3072
  ds_read_b64_tr_b16 v[26:27], v12 offset:3840
  s_add_u32 s38, s34, 32
  s_lshl_b32 s38, s38, 10
  s_add_i32 s38, s38, s70
  s_max_i32 s38, s38, 0
  s_add_u32 s38, s38, s69
  buffer_load_dwordx4 v[160:163], v3, s[20:23], s38 offen sc1
  s_waitcnt lgkmcnt(10)
  v_mfma_f32_32x32x16_bf16 v[80:95], v[28:31], v[220:223], v[80:95]
  ds_read_b64_tr_b16 v[28:29], v13 offset:3072
  ds_read_b64_tr_b16 v[30:31], v13 offset:3840
  s_add_u32 s38, s34, 40
  s_lshl_b32 s38, s38, 10
  s_add_i32 s38, s38, s70
  s_max_i32 s38, s38, 0
  s_add_u32 s38, s38, s69
  buffer_load_dwordx4 v[164:167], v3, s[20:23], s38 offen sc1
  s_waitcnt lgkmcnt(10)
  v_mfma_f32_32x32x16_bf16 v[48:63], v[32:35], v[224:227], v[48:63]
  ds_read_b64_tr_b16 v[32:33], v11 offset:6144
  ds_read_b64_tr_b16 v[34:35], v11 offset:6912
  s_add_u32 s38, s34, 48
  s_lshl_b32 s38, s38, 10
  s_add_i32 s38, s38, s70
  s_max_i32 s38, s38, 0
  s_add_u32 s38, s38, s69
  buffer_load_dwordx4 v[168:171], v3, s[20:23], s38 offen sc1
  s_waitcnt lgkmcnt(10)
  v_mfma_f32_32x32x16_bf16 v[64:79], v[36:39], v[224:227], v[64:79]
  ds_read_b64_tr_b16 v[36:37], v12 offset:6144
  ds_read_b64_tr_b16 v[38:39], v12 offset:6912
  s_add_u32 s38, s34, 56
  s_min_u32 s38, s38, 59
  s_lshl_b32 s38, s38, 10
  s_add_i32 s38, s38, s70
  s_max_i32 s38, s38, 0
  s_add_u32 s38, s38, s69
  buffer_load_dwordx4 v[172:175], v3, s[20:23], s38 offen sc1
  s_waitcnt lgkmcnt(10)
  v_mfma_f32_32x32x16_bf16 v[80:95], v[40:43], v[224:227], v[80:95]
  ds_read_b64_tr_b16 v[40:41], v13 offset:6144
  ds_read_b64_tr_b16 v[42:43], v13 offset:6912
  v_and_b32 v19, 31, v0
  v_lshrrev_b32 v22, 5, v0
  v_lshlrev_b32 v19, 4, v19
  v_lshl_add_u32 v2, v22, 3, v19
  v_lshl_add_u32 v1, v22, 9, v19
  s_mul_i32 s41, s36, 1536
  v_add_u32 v1, s41, v1
  s_lshl_b32 s41, s32, 2
  s_add_u32 s41, s41, s35
  s_mul_i32 s41, s41, 2560
  s_mul_i32 s42, s33, 163840
  s_add_u32 s41, s41, s42
  buffer_load_dwordx4 v[176:179], v1, s[20:23], s41 offen sc1
  buffer_load_dwordx2 v[180:181], v2, s[20:23], s41 offen offset:1024 sc1
  s_waitcnt lgkmcnt(10)
  v_mfma_f32_32x32x16_bf16 v[48:63], v[44:47], v[228:231], v[48:63]
  ds_read_b64_tr_b16 v[44:45], v11 offset:9216
  ds_read_b64_tr_b16 v[46:47], v11 offset:9984
  s_waitcnt lgkmcnt(10)
  v_mfma_f32_32x32x16_bf16 v[64:79], v[24:27], v[228:231], v[64:79]
  ds_read_b64_tr_b16 v[24:25], v12 offset:9216
  ds_read_b64_tr_b16 v[26:27], v12 offset:9984
  s_min_u32 s38, s34, 2
  s_lshl_b32 s38, s38, 8
  v_lshl_add_u32 v16, v0, 2, s38
  s_mul_i32 s38, s33, 2560
  v_lshl_add_u32 v17, v16, 1, s38
  s_waitcnt lgkmcnt(10)
  v_mfma_f32_32x32x16_bf16 v[80:95], v[28:31], v[228:231], v[80:95]
  ds_read_b64_tr_b16 v[28:29], v13 offset:9216
  ds_read_b64_tr_b16 v[30:31], v13 offset:9984
  s_mov_b32 s38, 21038080
  buffer_load_dwordx2 v[96:97], v17, s[20:23], s38 offen sc1
  s_waitcnt lgkmcnt(10)
  v_mfma_f32_32x32x16_bf16 v[48:63], v[32:35], v[232:235], v[48:63]
  s_barrier
  ds_read_b64_tr_b16 v[32:33], v11 offset:24576
  ds_read_b64_tr_b16 v[34:35], v11 offset:25344
  s_mov_b32 s38, 21079040
  buffer_load_dwordx2 v[98:99], v17, s[20:23], s38 offen sc1
  s_waitcnt lgkmcnt(10)
  v_mfma_f32_32x32x16_bf16 v[64:79], v[36:39], v[232:235], v[64:79]
  ds_read_b64_tr_b16 v[36:37], v12 offset:24576
  ds_read_b64_tr_b16 v[38:39], v12 offset:25344
  s_mov_b32 s38, 21120000
  buffer_load_dwordx2 v[100:101], v17, s[20:23], s38 offen sc1
  s_waitcnt lgkmcnt(10)
  v_mfma_f32_32x32x16_bf16 v[80:95], v[40:43], v[232:235], v[80:95]
  ds_read_b64_tr_b16 v[40:41], v13 offset:24576
  ds_read_b64_tr_b16 v[42:43], v13 offset:25344
  s_mov_b32 s38, 21160960
  buffer_load_dwordx2 v[102:103], v17, s[20:23], s38 offen sc1
  s_waitcnt lgkmcnt(10)
  v_mfma_f32_32x32x16_bf16 v[48:63], v[44:47], v[236:239], v[48:63]
  ds_read_b64_tr_b16 v[44:45], v11 offset:27648
  ds_read_b64_tr_b16 v[46:47], v11 offset:28416
  s_mov_b32 s38, 21201920
  buffer_load_dwordx2 v[104:105], v17, s[20:23], s38 offen sc1
  s_waitcnt lgkmcnt(10)
  v_mfma_f32_32x32x16_bf16 v[64:79], v[24:27], v[236:239], v[64:79]
  ds_read_b64_tr_b16 v[24:25], v12 offset:27648
  ds_read_b64_tr_b16 v[26:27], v12 offset:28416
  s_mul_i32 s70, s35, 20480
  s_add_u32 s70, s70, 81920
  s_lshl_b32 s69, s35, 12
  s_add_u32 s69, s69, 65536
  s_add_u32 s39, s70, 16384
  s_add_u32 s40, s70, 8192
  s_cmp_eq_u32 s36, 0
  s_cselect_b32 s69, s69, s39
  s_cselect_b32 s70, s70, s40
  s_cmp_eq_u32 s34, 0
  s_cselect_b32 s70, 94208, s70
  s_cmp_eq_u32 s34, 4
  s_cselect_b32 s69, 81920, s69
  s_cselect_b32 s70, 86016, s70
  s_mul_i32 s38, s45, 68
  s_add_u32 s38, s38, s34
  s_mul_i32 s38, s38, 5120
  v_lshl_add_u32 v196, v0, 4, s38
  s_waitcnt lgkmcnt(10)
  v_mfma_f32_32x32x16_bf16 v[80:95], v[28:31], v[236:239], v[80:95]
  ds_read_b64_tr_b16 v[28:29], v13 offset:27648
  ds_read_b64_tr_b16 v[30:31], v13 offset:28416
  s_add_u32 m0, s69, 0
  s_mov_b32 s39, 16982016
  buffer_load_dwordx4 v196, s[20:23], s39 offen sc1 lds
  s_waitcnt lgkmcnt(10)
  v_mfma_f32_32x32x16_bf16 v[48:63], v[32:35], v[240:243], v[48:63]
  ds_read_b64_tr_b16 v[32:33], v11 offset:30720
  ds_read_b64_tr_b16 v[34:35], v11 offset:31488
  s_waitcnt lgkmcnt(10)
  v_mfma_f32_32x32x16_bf16 v[64:79], v[36:39], v[240:243], v[64:79]
  ds_read_b64_tr_b16 v[36:37], v12 offset:30720
  ds_read_b64_tr_b16 v[38:39], v12 offset:31488
  s_waitcnt lgkmcnt(10)
  v_mfma_f32_32x32x16_bf16 v[80:95], v[40:43], v[240:243], v[80:95]
  ds_read_b64_tr_b16 v[40:41], v13 offset:30720
  ds_read_b64_tr_b16 v[42:43], v13 offset:31488
  s_add_u32 m0, s69, 1024
  s_mov_b32 s39, 16983040
  buffer_load_dwordx4 v196, s[20:23], s39 offen sc1 lds
  s_waitcnt lgkmcnt(10)
  v_mfma_f32_32x32x16_bf16 v[48:63], v[44:47], v[244:247], v[48:63]
  ds_read_b64_tr_b16 v[44:45], v11 offset:33792
  ds_read_b64_tr_b16 v[46:47], v11 offset:34560
  s_waitcnt lgkmcnt(10)
  v_mfma_f32_32x32x16_bf16 v[64:79], v[24:27], v[244:247], v[64:79]
  ds_read_b64_tr_b16 v[24:25], v12 offset:33792
  ds_read_b64_tr_b16 v[26:27], v12 offset:34560
  s_waitcnt lgkmcnt(10)
  v_mfma_f32_32x32x16_bf16 v[80:95], v[28:31], v[244:247], v[80:95]
  ds_read_b64_tr_b16 v[28:29], v13 offset:33792
  ds_read_b64_tr_b16 v[30:31], v13 offset:34560
  s_add_u32 m0, s69, 2048
  s_mov_b32 s39, 16984064
  buffer_load_dwordx4 v196, s[20:23], s39 offen sc1 lds
  s_waitcnt lgkmcnt(10)
  v_mfma_f32_32x32x16_bf16 v[48:63], v[32:35], v[248:251], v[48:63]
  s_waitcnt lgkmcnt(8)
  v_mfma_f32_32x32x16_bf16 v[64:79], v[36:39], v[248:251], v[64:79]
  s_waitcnt lgkmcnt(6)
  v_mfma_f32_32x32x16_bf16 v[80:95], v[40:43], v[248:251], v[80:95]
  s_add_u32 m0, s69, 3072
  s_mov_b32 s39, 16985088
  buffer_load_dwordx4 v196, s[20:23], s39 offen sc1 lds
  s_waitcnt lgkmcnt(4)
  v_mfma_f32_32x32x16_bf16 v[48:63], v[44:47], v[252:255], v[48:63]
  s_waitcnt vmcnt(4)
  v_xor_b32 v97, s3, v97
  v_xor_b32 v99, s3, v99
  v_xor_b32 v101, s3, v101
  v_xor_b32 v103, s3, v103
  v_xor_b32 v105, s3, v105
  v_or3_b32 v97, v97, v99, v101
  v_or3_b32 v97, v97, v103, v105
  v_cmp_ne_u32 vcc, 0, v97
  s_cbranch_vccnz SP_16
RT_17:
  v_add_f32 v96, v96, v98
  v_add_f32 v100, v100, v102
  v_add_f32 v96, v96, v104
  v_add_f32 v96, v96, v100
  ds_write_b32 v16, v96 offset:512
  s_waitcnt lgkmcnt(3)
  v_mfma_f32_32x32x16_bf16 v[64:79], v[24:27], v[252:255], v[64:79]
  s_waitcnt lgkmcnt(1)
  v_mfma_f32_32x32x16_bf16 v[80:95], v[28:31], v[252:255], v[80:95]
  s_waitcnt lgkmcnt(0)
  s_barrier
  s_mul_i32 s38, s44, 278528
  s_lshl_b32 s39, s34, 10
  s_add_u32 s38, s38, s39
  v_lshl_add_u32 v13, v0, 4, s38
  s_mul_i32 s38, s45, 68
  s_add_u32 s38, s38, s34
  s_mul_i32 s38, s38, 5120
  v_lshl_add_u32 v11, v0, 4, s38
  s_lshr_b32 s38, s44, 1
  s_lshl_b32 s38, s38, 12
  s_add_u32 s38, s38, 21364736
  v_and_b32 v7, 15, v0
  v_lshl_add_u32 v7, v7, 8, s38
  s_add_u32 m0, s70, 0
  s_mov_b32 s39, 16986112
  buffer_load_dwordx4 v11, s[20:23], s39 offen sc1 lds
  s_add_u32 m0, s70, 1024
  s_mov_b32 s39, 17022976
  buffer_load_dwordx4 v11, s[20:23], s39 offen sc1 lds
  s_add_u32 m0, s70, 2048
  s_mov_b32 s39, 17024000
  buffer_load_dwordx4 v11, s[20:23], s39 offen sc1 lds
  s_add_u32 m0, s70, 3072
  s_mov_b32 s39, 17025024
  buffer_load_dwordx4 v11, s[20:23], s39 offen sc1 lds
  v_lshrrev_b32 v19, 5, v0
  s_mul_i32 s38, s36, 384
  v_lshl_add_u32 v22, v19, 6, s38
  ds_read_b128 v[96:99], v22 offset:512
  ds_read_b128 v[100:103], v22 offset:528
  ds_read_b128 v[104:107], v22 offset:544
  ds_read_b128 v[108:111], v22 offset:560
  ds_read_b128 v[112:115], v22 offset:640
  ds_read_b128 v[116:119], v22 offset:656
  ds_read_b128 v[120:123], v22 offset:672
  ds_read_b128 v[124:127], v22 offset:688
  ds_read_b128 v[128:131], v22 offset:768
  ds_read_b128 v[132:135], v22 offset:784
  ds_read_b128 v[136:139], v22 offset:800
  ds_read_b128 v[140:143], v22 offset:816
  v_mul_f32 v14, v21, v21
  v_bfe_u32 v23, v0, 4, 1
  v_mul_u32_u24 v23, 69632, v23
  v_lshl_add_u32 v23, v19, 8, v23
  v_and_b32 v19, 15, v0
  v_lshl_add_u32 v23, v19, 4, v23
  s_lshl_b32 s39, s32, 2
  s_add_u32 s39, s39, s35
  s_mul_i32 s39, s39, 139264
  s_lshl_b32 s40, s33, 1
  s_add_u32 s40, s40, s36
  s_mul_i32 s40, s40, 1536
  s_add_u32 s39, s39, s40
  s_add_u32 s39, s39, 7864320
  s_waitcnt lgkmcnt(8)
  v_pk_fma_f32 v[48:49], v[96:97], v[20:21], v[48:49] op_sel_hi:[1,0,1]
  v_pk_fma_f32 v[50:51], v[98:99], v[20:21], v[50:51] op_sel_hi:[1,0,1]
  v_pk_fma_f32 v[52:53], v[100:101], v[20:21], v[52:53] op_sel_hi:[1,0,1]
  v_pk_fma_f32 v[54:55], v[102:103], v[20:21], v[54:55] op_sel_hi:[1,0,1]
  v_pk_fma_f32 v[56:57], v[104:105], v[20:21], v[56:57] op_sel_hi:[1,0,1]
  v_pk_fma_f32 v[58:59], v[106:107], v[20:21], v[58:59] op_sel_hi:[1,0,1]
  v_pk_fma_f32 v[60:61], v[108:109], v[20:21], v[60:61] op_sel_hi:[1,0,1]
  v_pk_fma_f32 v[62:63], v[110:111], v[20:21], v[62:63] op_sel_hi:[1,0,1]
  v_pk_mul_f32 v[48:49], v[48:49], v[14:15] op_sel_hi:[1,0]
  v_pk_mul_f32 v[50:51], v[50:51], v[14:15] op_sel_hi:[1,0]
  v_pk_mul_f32 v[52:53], v[52:53], v[14:15] op_sel_hi:[1,0]
  v_pk_mul_f32 v[54:55], v[54:55], v[14:15] op_sel_hi:[1,0]
  v_pk_mul_f32 v[48:49], v[48:49], v[56:57]
  v_pk_mul_f32 v[50:51], v[50:51], v[58:59]
  v_pk_mul_f32 v[52:53], v[52:53], v[60:61]
  v_pk_mul_f32 v[54:55], v[54:55], v[62:63]
  v_cvt_pk_bf16_f32 v48, v48, v49
  v_cvt_pk_bf16_f32 v49, v50, v51
  v_cvt_pk_bf16_f32 v50, v52, v53
  v_cvt_pk_bf16_f32 v51, v54, v55
  buffer_store_dwordx4 v[48:51], v23, s[20:23], s39 offen offset:0 sc1
  s_waitcnt lgkmcnt(4)
  v_pk_fma_f32 v[64:65], v[112:113], v[20:21], v[64:65] op_sel_hi:[1,0,1]
  v_pk_fma_f32 v[66:67], v[114:115], v[20:21], v[66:67] op_sel_hi:[1,0,1]
  v_pk_fma_f32 v[68:69], v[116:117], v[20:21], v[68:69] op_sel_hi:[1,0,1]
  v_pk_fma_f32 v[70:71], v[118:119], v[20:21], v[70:71] op_sel_hi:[1,0,1]
  v_pk_fma_f32 v[72:73], v[120:121], v[20:21], v[72:73] op_sel_hi:[1,0,1]
  v_pk_fma_f32 v[74:75], v[122:123], v[20:21], v[74:75] op_sel_hi:[1,0,1]
  v_pk_fma_f32 v[76:77], v[124:125], v[20:21], v[76:77] op_sel_hi:[1,0,1]
  v_pk_fma_f32 v[78:79], v[126:127], v[20:21], v[78:79] op_sel_hi:[1,0,1]
  v_pk_mul_f32 v[64:65], v[64:65], v[14:15] op_sel_hi:[1,0]
  v_pk_mul_f32 v[66:67], v[66:67], v[14:15] op_sel_hi:[1,0]
  v_pk_mul_f32 v[68:69], v[68:69], v[14:15] op_sel_hi:[1,0]
  v_pk_mul_f32 v[70:71], v[70:71], v[14:15] op_sel_hi:[1,0]
  v_pk_mul_f32 v[64:65], v[64:65], v[72:73]
  v_pk_mul_f32 v[66:67], v[66:67], v[74:75]
  v_pk_mul_f32 v[68:69], v[68:69], v[76:77]
  v_pk_mul_f32 v[70:71], v[70:71], v[78:79]
  v_cvt_pk_bf16_f32 v64, v64, v65
  v_cvt_pk_bf16_f32 v65, v66, v67
  v_cvt_pk_bf16_f32 v66, v68, v69
  v_cvt_pk_bf16_f32 v67, v70, v71
  buffer_store_dwordx4 v[64:67], v23, s[20:23], s39 offen offset:512 sc1
  s_waitcnt lgkmcnt(0)
  v_pk_fma_f32 v[80:81], v[128:129], v[20:21], v[80:81] op_sel_hi:[1,0,1]
  v_pk_fma_f32 v[82:83], v[130:131], v[20:21], v[82:83] op_sel_hi:[1,0,1]
  v_pk_fma_f32 v[84:85], v[132:133], v[20:21], v[84:85] op_sel_hi:[1,0,1]
  v_pk_fma_f32 v[86:87], v[134:135], v[20:21], v[86:87] op_sel_hi:[1,0,1]
  v_pk_fma_f32 v[88:89], v[136:137], v[20:21], v[88:89] op_sel_hi:[1,0,1]
  v_pk_fma_f32 v[90:91], v[138:139], v[20:21], v[90:91] op_sel_hi:[1,0,1]
  v_pk_fma_f32 v[92:93], v[140:141], v[20:21], v[92:93] op_sel_hi:[1,0,1]
  v_pk_fma_f32 v[94:95], v[142:143], v[20:21], v[94:95] op_sel_hi:[1,0,1]
  v_pk_mul_f32 v[80:81], v[80:81], v[14:15] op_sel_hi:[1,0]
  v_pk_mul_f32 v[82:83], v[82:83], v[14:15] op_sel_hi:[1,0]
  v_pk_mul_f32 v[84:85], v[84:85], v[14:15] op_sel_hi:[1,0]
  v_pk_mul_f32 v[86:87], v[86:87], v[14:15] op_sel_hi:[1,0]
  v_pk_mul_f32 v[80:81], v[80:81], v[88:89]
  v_pk_mul_f32 v[82:83], v[82:83], v[90:91]
  v_pk_mul_f32 v[84:85], v[84:85], v[92:93]
  v_pk_mul_f32 v[86:87], v[86:87], v[94:95]
  v_cvt_pk_bf16_f32 v80, v80, v81
  v_cvt_pk_bf16_f32 v81, v82, v83
  v_cvt_pk_bf16_f32 v82, v84, v85
  v_cvt_pk_bf16_f32 v83, v86, v87
  buffer_store_dwordx4 v[80:83], v23, s[20:23], s39 offen offset:1024 sc1
  s_lshl_b32 s38, s34, 10
  v_add_u32 v8, s38, v3
  s_min_u32 s38, s38, 3072
  v_add_u32 v9, s38, v3
  ds_write_b128 v8, v[144:147] offset:4096
  ds_write_b128 v8, v[148:151] offset:12288
  ds_write_b128 v8, v[152:155] offset:20480
  ds_write_b128 v8, v[156:159] offset:28672
  ds_write_b128 v8, v[160:163] offset:36864
  ds_write_b128 v8, v[164:167] offset:45056
  ds_write_b128 v8, v[168:171] offset:53248
  ds_write_b128 v9, v[172:175] offset:61440
  v_mov_b32 v24, v176
  v_mov_b32 v25, v177
  v_mov_b32 v26, v178
  v_mov_b32 v27, v179
  v_mov_b32 v28, v180
  v_mov_b32 v29, v181
  s_setprio 2
  s_mul_i32 s41, s35, 5120
  s_add_u32 s41, s41, 4096
  v_add_u32 v1, s41, v1
  v_add_u32 v2, s41, v2
  v_and_b32 v8, 3, v0
  v_bfe_u32 v9, v0, 2, 1
  v_lshl_add_u32 v10, v9, 3, v8
  v_bfe_u32 v9, v0, 3, 1
  v_lshl_add_u32 v10, v9, 2, v10
  s_mul_i32 s42, s36, 24
  v_add_u32 v10, s42, v10
  s_lshl_b32 s42, s36, 2
  s_add_u32 s42, s42, 16
  v_add_u32 v8, s42, v8
  v_and_b32 v9, 16, v0
  v_cmp_eq_u32 vcc, 0, v9
  v_lshrrev_b32 v9, 5, v0
  v_mul_u32_u24 v9, 640, v9
  v_cndmask_b32 v10, v8, v10, vcc
  v_lshl_add_u32 v3, v10, 4, v9
  v_add_u32 v3, s41, v3
  v_mov_b32 v48, s37
  v_mov_b32 v49, s37
  v_mov_b32 v50, s37
  v_mov_b32 v51, s37
  v_mov_b32 v52, s37
  v_mov_b32 v53, s37
  v_mov_b32 v54, s37
  v_mov_b32 v55, s37
  v_mov_b32 v56, s37
  v_mov_b32 v57, s37
  v_mov_b32 v58, s37
  v_mov_b32 v59, s37
  v_mov_b32 v60, s37
  v_mov_b32 v61, s37
  v_mov_b32 v62, s37
  v_mov_b32 v63, s37
  s_mov_b32 s72, 0x000fffff
  s_mov_b32 s73, 0x000fffff
  v_and_b32 v8, 31, v0
  v_lshrrev_b32 v9, 5, v0
  v_lshlrev_b32 v9, 2, v9
  v_sub_u32 v8, v8, v9
  v_mov_b32 v9, 0xf149f2ca
  v_mov_b32 v10, 0
  v_cmp_gt_i32 vcc, 0, v8
  s_nop 0
  v_cmp_gt_i32 s[74:75], 1, v8
  v_cndmask_b32 v96, v9, v10, vcc
  v_cndmask_b32 v224, v10, v9, vcc
  s_add_u32 m0, s70, 4096
  s_mov_b32 s39, 17026048
  buffer_load_dwordx4 v11, s[20:23], s39 offen sc1 lds
  v_cmp_gt_i32 vcc, 2, v8
  v_cndmask_b32 v97, v9, v10, s[74:75]
  v_cndmask_b32 v225, v10, v9, s[74:75]
  v_cmp_gt_i32 s[74:75], 3, v8
  v_cndmask_b32 v98, v9, v10, vcc
  v_cndmask_b32 v226, v10, v9, vcc
  s_add_u32 m0, s70, 5120
  s_mov_b32 s39, 17027072
  buffer_load_dwordx4 v11, s[20:23], s39 offen sc1 lds
  v_cmp_gt_i32 vcc, 8, v8
  v_cndmask_b32 v99, v9, v10, s[74:75]
  v_cndmask_b32 v227, v10, v9, s[74:75]
  v_cmp_gt_i32 s[74:75], 9, v8
  v_cndmask_b32 v100, v9, v10, vcc
  v_cndmask_b32 v228, v10, v9, vcc
  s_add_u32 m0, s70, 6144
  s_mov_b32 s39, 17063936
  buffer_load_dwordx4 v11, s[20:23], s39 offen sc1 lds
  v_cmp_gt_i32 vcc, 10, v8
  v_cndmask_b32 v101, v9, v10, s[74:75]
  v_cndmask_b32 v229, v10, v9, s[74:75]
  v_cmp_gt_i32 s[74:75], 11, v8
  v_cndmask_b32 v102, v9, v10, vcc
  v_cndmask_b32 v230, v10, v9, vcc
  s_add_u32 m0, s70, 7168
  s_mov_b32 s39, 17064960
  buffer_load_dwordx4 v11, s[20:23], s39 offen sc1 lds
  v_cmp_gt_i32 vcc, 16, v8
  v_cndmask_b32 v103, v9, v10, s[74:75]
  v_cndmask_b32 v231, v10, v9, s[74:75]
  v_cmp_gt_i32 s[74:75], 17, v8
  v_cndmask_b32 v104, v9, v10, vcc
  v_cndmask_b32 v232, v10, v9, vcc
  v_cmp_gt_i32 vcc, 18, v8
  v_cndmask_b32 v105, v9, v10, s[74:75]
  v_cndmask_b32 v233, v10, v9, s[74:75]
  v_cmp_gt_i32 s[74:75], 19, v8
  v_cndmask_b32 v106, v9, v10, vcc
  v_cndmask_b32 v234, v10, v9, vcc
  v_cmp_gt_i32 vcc, 24, v8
  v_cndmask_b32 v107, v9, v10, s[74:75]
  v_cndmask_b32 v235, v10, v9, s[74:75]
  v_cmp_gt_i32 s[74:75], 25, v8
  v_cndmask_b32 v108, v9, v10, vcc
  v_cndmask_b32 v236, v10, v9, vcc
  v_cmp_gt_i32 vcc, 26, v8
  v_cndmask_b32 v109, v9, v10, s[74:75]
  v_cndmask_b32 v237, v10, v9, s[74:75]
  v_cmp_gt_i32 s[74:75], 27, v8
  v_cndmask_b32 v110, v9, v10, vcc
  v_cndmask_b32 v238, v10, v9, vcc
  v_cndmask_b32 v111, v9, v10, s[74:75]
  v_cndmask_b32 v239, v10, v9, s[74:75]
  s_sub_u32 s74, s36, 1
  s_not_b32 s75, s74
  s_waitcnt lgkmcnt(0)
  s_barrier
  ds_read_b128 v[30:33], v1 offset:0
  ds_read_b64 v[34:35], v2 offset:1024
  ds_read_b128 v[36:39], v1 offset:5120
  ds_read_b64 v[40:41], v2 offset:6144
  v_cndmask_b32 v28, v10, v28, s[74:75]
  v_cndmask_b32 v29, v10, v29, s[74:75]
  v_mov_b32 v4, v9
  v_mov_b32 v5, v9
  ds_read_b128 v[42:45], v1 offset:10240
  ds_read_b64 v[46:47], v2 offset:11264
  s_waitcnt lgkmcnt(4)
  v_mfma_f32_32x32x16_bf16 v[96:111], v[30:33], v[24:27], v[96:111]
  v_mfma_f32_32x32x8bf16_1k v[96:111], v[34:35], v[28:29], v[96:111]
  s_mov_b32 s39, 16777216
  buffer_load_dwordx4 v[80:83], v11, s[20:23], s39 offen sc1
  ds_read_b128 v[30:33], v1 offset:15360
  ds_read_b64 v[34:35], v2 offset:16384
  s_waitcnt lgkmcnt(4)
  v_mfma_f32_32x32x16_bf16 v[112:127], v[36:39], v[24:27], 0
  v_mfma_f32_32x32x8bf16_1k v[112:127], v[40:41], v[28:29], v[112:127]
  s_mov_b32 s39, 16778240
  buffer_load_dwordx4 v[84:87], v11, s[20:23], s39 offen sc1
  ds_read_b128 v[36:39], v1 offset:20480
  ds_read_b64 v[40:41], v2 offset:21504
  s_waitcnt lgkmcnt(4)
  v_mfma_f32_32x32x16_bf16 v[128:143], v[42:45], v[24:27], 0
  v_mfma_f32_32x32x8bf16_1k v[128:143], v[46:47], v[28:29], v[128:143]
  s_mov_b32 s39, 16779264
  buffer_load_dwordx4 v[88:91], v11, s[20:23], s39 offen sc1
  ds_read_b128 v[42:45], v1 offset:25600
  ds_read_b64 v[46:47], v2 offset:26624
  s_waitcnt lgkmcnt(4)
  v_mfma_f32_32x32x16_bf16 v[144:159], v[30:33], v[24:27], 0
  v_mfma_f32_32x32x8bf16_1k v[144:159], v[34:35], v[28:29], v[144:159]
  s_mov_b32 s39, 16780288
  buffer_load_dwordx4 v[92:95], v11, s[20:23], s39 offen sc1
  ds_read_b128 v[30:33], v1 offset:30720
  ds_read_b64 v[34:35], v2 offset:31744
  s_waitcnt lgkmcnt(4)
  v_mfma_f32_32x32x16_bf16 v[160:175], v[36:39], v[24:27], 0
  v_mfma_f32_32x32x8bf16_1k v[160:175], v[40:41], v[28:29], v[160:175]
  s_mov_b32 s39, 16781312
  buffer_load_dwordx4 v[240:243], v11, s[20:23], s39 offen sc1
  ds_read_b128 v[36:39], v1 offset:35840
  ds_read_b64 v[40:41], v2 offset:36864
  s_waitcnt lgkmcnt(4)
  v_mfma_f32_32x32x16_bf16 v[176:191], v[42:45], v[24:27], 0
  v_mfma_f32_32x32x8bf16_1k v[176:191], v[46:47], v[28:29], v[176:191]
  s_mov_b32 s39, 16818176
  buffer_load_dwordx4 v[244:247], v11, s[20:23], s39 offen sc1
  ds_read_b128 v[42:45], v1 offset:40960
  ds_read_b64 v[46:47], v2 offset:41984
  s_waitcnt lgkmcnt(4)
  v_mfma_f32_32x32x16_bf16 v[192:207], v[30:33], v[24:27], 0
  v_mfma_f32_32x32x8bf16_1k v[192:207], v[34:35], v[28:29], v[192:207]
  s_mov_b32 s39, 16819200
  buffer_load_dwordx4 v[248:251], v11, s[20:23], s39 offen sc1
  s_waitcnt lgkmcnt(2)
  v_mfma_f32_32x32x16_bf16 v[208:223], v[36:39], v[24:27], 0
  v_mfma_f32_32x32x8bf16_1k v[208:223], v[40:41], v[28:29], v[208:223]
  s_mov_b32 s39, 16820224
  buffer_load_dwordx4 v[252:255], v11, s[20:23], s39 offen sc1
  s_waitcnt lgkmcnt(0)
  v_mfma_f32_32x32x16_bf16 v[224:239], v[42:45], v[24:27], v[224:239]
  v_mfma_f32_32x32x8bf16_1k v[224:239], v[46:47], v[28:29], v[224:239]
  s_mov_b32 s39, 16821248
  buffer_load_dwordx4 v[20:23], v11, s[20:23], s39 offen sc1
  s_mov_b64 exec, s[72:73]
  ds_read_b128 v[48:51], v3 offset:2560
  ds_read_b128 v[52:55], v3 offset:3840
  ds_read_b128 v[56:59], v3 offset:7680
  ds_read_b128 v[60:63], v3 offset:8960
  s_mov_b64 exec, -1
  s_lshl_b32 s41, s32, 2
  s_add_u32 s41, s41, s35
  s_cmp_ge_u32 s41, 8
  s_cbranch_scc1 L_19
  s_nop 7
  s_nop 7
  v_mov_b32 v96, v9
  v_mov_b32 v97, v9
  v_mov_b32 v98, v9
  v_mov_b32 v99, v9
  v_mov_b32 v100, v9
  v_mov_b32 v101, v9
  v_mov_b32 v102, v9
  v_mov_b32 v103, v9
  v_mov_b32 v104, v9
  v_mov_b32 v105, v9
  v_mov_b32 v106, v9
  v_mov_b32 v107, v9
  v_mov_b32 v108, v9
  v_mov_b32 v109, v9
  v_mov_b32 v110, v9
  v_mov_b32 v111, v9
  s_cmp_ge_u32 s41, 7
  s_cbranch_scc1 L_19
  v_mov_b32 v112, v9
  v_mov_b32 v113, v9
  v_mov_b32 v114, v9
  v_mov_b32 v115, v9
  v_mov_b32 v116, v9
  v_mov_b32 v117, v9
  v_mov_b32 v118, v9
  v_mov_b32 v119, v9
  v_mov_b32 v120, v9
  v_mov_b32 v121, v9
  v_mov_b32 v122, v9
  v_mov_b32 v123, v9
  v_mov_b32 v124, v9
  v_mov_b32 v125, v9
  v_mov_b32 v126, v9
  v_mov_b32 v127, v9
  s_cmp_ge_u32 s41, 6
  s_cbranch_scc1 L_19
  v_mov_b32 v128, v9
  v_mov_b32 v129, v9
  v_mov_b32 v130, v9
  v_mov_b32 v131, v9
  v_mov_b32 v132, v9
  v_mov_b32 v133, v9
  v_mov_b32 v134, v9
  v_mov_b32 v135, v9
  v_mov_b32 v136, v9
  v_mov_b32 v137, v9
  v_mov_b32 v138, v9
  v_mov_b32 v139, v9
  v_mov_b32 v140, v9
  v_mov_b32 v141, v9
  v_mov_b32 v142, v9
  v_mov_b32 v143, v9
  s_cmp_ge_u32 s41, 5
  s_cbranch_scc1 L_19
  v_mov_b32 v144, v9
  v_mov_b32 v145, v9
  v_mov_b32 v146, v9
  v_mov_b32 v147, v9
  v_mov_b32 v148, v9
  v_mov_b32 v149, v9
  v_mov_b32 v150, v9
  v_mov_b32 v151, v9
  v_mov_b32 v152, v9
  v_mov_b32 v153, v9
  v_mov_b32 v154, v9
  v_mov_b32 v155, v9
  v_mov_b32 v156, v9
  v_mov_b32 v157, v9
  v_mov_b32 v158, v9
  v_mov_b32 v159, v9
  s_cmp_ge_u32 s41, 4
  s_cbranch_scc1 L_19
  v_mov_b32 v160, v9
  v_mov_b32 v161, v9
  v_mov_b32 v162, v9
  v_mov_b32 v163, v9
  v_mov_b32 v164, v9
  v_mov_b32 v165, v9
  v_mov_b32 v166, v9
  v_mov_b32 v167, v9
  v_mov_b32 v168, v9
  v_mov_b32 v169, v9
  v_mov_b32 v170, v9
  v_mov_b32 v171, v9
  v_mov_b32 v172, v9
  v_mov_b32 v173, v9
  v_mov_b32 v174, v9
  v_mov_b32 v175, v9
  s_cmp_ge_u32 s41, 3
  s_cbranch_scc1 L_19
  v_mov_b32 v176, v9
  v_mov_b32 v177, v9
  v_mov_b32 v178, v9
  v_mov_b32 v179, v9
  v_mov_b32 v180, v9
  v_mov_b32 v181, v9
  v_mov_b32 v182, v9
  v_mov_b32 v183, v9
  v_mov_b32 v184, v9
  v_mov_b32 v185, v9
  v_mov_b32 v186, v9
  v_mov_b32 v187, v9
  v_mov_b32 v188, v9
  v_mov_b32 v189, v9
  v_mov_b32 v190, v9
  v_mov_b32 v191, v9
  s_cmp_ge_u32 s41, 2
  s_cbranch_scc1 L_19
  v_mov_b32 v192, v9
  v_mov_b32 v193, v9
  v_mov_b32 v194, v9
  v_mov_b32 v195, v9
  v_mov_b32 v196, v9
  v_mov_b32 v197, v9
  v_mov_b32 v198, v9
  v_mov_b32 v199, v9
  v_mov_b32 v200, v9
  v_mov_b32 v201, v9
  v_mov_b32 v202, v9
  v_mov_b32 v203, v9
  v_mov_b32 v204, v9
  v_mov_b32 v205, v9
  v_mov_b32 v206, v9
  v_mov_b32 v207, v9
  s_cmp_ge_u32 s41, 1
  s_cbranch_scc1 L_19
  v_mov_b32 v208, v9
  v_mov_b32 v209, v9
  v_mov_b32 v210, v9
  v_mov_b32 v211, v9
  v_mov_b32 v212, v9
  v_mov_b32 v213, v9
  v_mov_b32 v214, v9
  v_mov_b32 v215, v9
  v_mov_b32 v216, v9
  v_mov_b32 v217, v9
  v_mov_b32 v218, v9
  v_mov_b32 v219, v9
  v_mov_b32 v220, v9
  v_mov_b32 v221, v9
  v_mov_b32 v222, v9
  v_mov_b32 v223, v9
L_19:
  s_waitcnt vmcnt(13)
  s_barrier
  v_lshl_add_u32 v14, v0, 2, s79
  s_add_u32 s38, s3, 2
  v_mov_b32 v15, s38
  buffer_store_dword v15, v14, s[20:23], 0 offen sc1
  v_mov_b32 v8, 0xbf00bf00
  v_mov_b32 v9, 0xbf00bf00
  v_max3_f32 v4, v96, v97, v4
  v_max3_f32 v5, v98, v99, v5
  v_max3_f32 v4, v100, v101, v4
  v_max3_f32 v5, v102, v103, v5
  v_max3_f32 v4, v104, v105, v4
  v_max3_f32 v5, v106, v107, v5
  v_max3_f32 v4, v108, v109, v4
  v_max3_f32 v5, v110, v111, v5
  s_mov_b32 s39, 16822272
  buffer_load_dwordx4 v[24:27], v11, s[20:23], s39 offen sc1
  v_max3_f32 v4, v112, v113, v4
  v_max3_f32 v5, v114, v115, v5
  v_max3_f32 v4, v116, v117, v4
  v_max3_f32 v5, v118, v119, v5
  v_max3_f32 v4, v120, v121, v4
  v_max3_f32 v5, v122, v123, v5
  v_max3_f32 v4, v124, v125, v4
  v_max3_f32 v5, v126, v127, v5
  s_mov_b32 s39, 16859136
  buffer_load_dwordx4 v[28:31], v11, s[20:23], s39 offen sc1
  v_max3_f32 v4, v128, v129, v4
  v_max3_f32 v5, v130, v131, v5
  v_max3_f32 v4, v132, v133, v4
  v_max3_f32 v5, v134, v135, v5
  v_max3_f32 v4, v136, v137, v4
  v_max3_f32 v5, v138, v139, v5
  v_max3_f32 v4, v140, v141, v4
  v_max3_f32 v5, v142, v143, v5
  s_mov_b32 s39, 16860160
  buffer_load_dwordx4 v[32:35], v11, s[20:23], s39 offen sc1
  v_max3_f32 v4, v144, v145, v4
  v_max3_f32 v5, v146, v147, v5
  v_max3_f32 v4, v148, v149, v4
  v_max3_f32 v5, v150, v151, v5
  v_max3_f32 v4, v152, v153, v4
  v_max3_f32 v5, v154, v155, v5
  v_max3_f32 v4, v156, v157, v4
  v_max3_f32 v5, v158, v159, v5
  s_mov_b32 s39, 16861184
  buffer_load_dwordx4 v[36:39], v11, s[20:23], s39 offen sc1
  v_max3_f32 v4, v160, v161, v4
  v_max3_f32 v5, v162, v163, v5
  v_max3_f32 v4, v164, v165, v4
  v_max3_f32 v5, v166, v167, v5
  v_max3_f32 v4, v168, v169, v4
  v_max3_f32 v5, v170, v171, v5
  v_max3_f32 v4, v172, v173, v4
  v_max3_f32 v5, v174, v175, v5
  s_mov_b32 s39, 16862208
  buffer_load_dwordx4 v[40:43], v11, s[20:23], s39 offen sc1
  v_max3_f32 v4, v176, v177, v4
  v_max3_f32 v5, v178, v179, v5
  v_max3_f32 v4, v180, v181, v4
  v_max3_f32 v5, v182, v183, v5
  v_max3_f32 v4, v184, v185, v4
  v_max3_f32 v5, v186, v187, v5
  v_max3_f32 v4, v188, v189, v4
  v_max3_f32 v5, v190, v191, v5
  s_mov_b32 s39, 16863232
  buffer_load_dwordx4 v[44:47], v11, s[20:23], s39 offen sc1
  v_max3_f32 v4, v192, v193, v4
  v_max3_f32 v5, v194, v195, v5
  v_max3_f32 v4, v196, v197, v4
  v_max3_f32 v5, v198, v199, v5
  v_max3_f32 v4, v200, v201, v4
  v_max3_f32 v5, v202, v203, v5
  v_max3_f32 v4, v204, v205, v4
  v_max3_f32 v5, v206, v207, v5
  v_max3_f32 v4, v208, v209, v4
  v_max3_f32 v5, v210, v211, v5
  v_max3_f32 v4, v212, v213, v4
  v_max3_f32 v5, v214, v215, v5
  v_max3_f32 v4, v216, v217, v4
  v_max3_f32 v5, v218, v219, v5
  v_max3_f32 v4, v220, v221, v4
  v_max3_f32 v5, v222, v223, v5
  s_nop 3
  v_max3_f32 v4, v224, v225, v4
  v_max3_f32 v5, v226, v227, v5
  v_max3_f32 v4, v228, v229, v4
  v_max3_f32 v5, v230, v231, v5
  v_max3_f32 v4, v232, v233, v4
  v_max3_f32 v5, v234, v235, v5
  v_max3_f32 v4, v236, v237, v4
  v_max3_f32 v5, v238, v239, v5
  v_max_f32 v4, v4, v5
  v_mov_b32 v5, v4
  s_nop 1
  v_permlane32_swap_b32 v4, v5
  s_nop 0
  v_max_f32 v4, v4, v5
  v_and_b32 v10, 0xffff0000, v4
  v_sub_f32 v5, v4, v10
  v_and_b32 v10, 0xffff0000, v5
  v_sub_f32 v5, v5, v10
  v_lshrrev_b32 v4, 16, v4
  v_or_b32 v4, v4, v10
  v_lshrrev_b32 v5, 16, v5
  s_nop 1
  v_mfma_f32_32x32x8bf16_1k v[96:111], v[8:9], v[4:5], v[96:111]
  s_nop 7
  s_nop 3
  v_mfma_f32_32x32x8bf16_1k v[112:127], v[8:9], v[4:5], v[112:127]
  v_exp_f32 v96, v96
  v_exp_f32 v97, v97
  v_exp_f32 v98, v98
  v_exp_f32 v99, v99
  v_exp_f32 v100, v100
  v_exp_f32 v101, v101
  v_exp_f32 v102, v102
  v_exp_f32 v103, v103
  s_nop 0
  v_cvt_pk_bf16_f32 v96, v96, v97
  v_cvt_pk_bf16_f32 v97, v98, v99
  v_cvt_pk_bf16_f32 v98, v100, v101
  v_cvt_pk_bf16_f32 v99, v102, v103
  s_mov_b32 s39, 16900096
  buffer_load_dwordx4 v[100:103], v11, s[20:23], s39 offen sc1
  v_exp_f32 v104, v104
  v_exp_f32 v105, v105
  v_exp_f32 v106, v106
  v_exp_f32 v107, v107
  v_exp_f32 v108, v108
  v_exp_f32 v109, v109
  v_exp_f32 v110, v110
  v_exp_f32 v111, v111
  s_waitcnt lgkmcnt(3)
  v_mfma_f32_32x32x16_bf16 v[64:79], v[48:51], v[96:99], 0
  v_cvt_pk_bf16_f32 v104, v104, v105
  v_cvt_pk_bf16_f32 v105, v106, v107
  v_cvt_pk_bf16_f32 v106, v108, v109
  v_cvt_pk_bf16_f32 v107, v110, v111
  s_mov_b32 s39, 16901120
  buffer_load_dwordx4 v[96:99], v11, s[20:23], s39 offen sc1
  s_mov_b32 s39, 16902144
  buffer_load_dwordx4 v[108:111], v11, s[20:23], s39 offen sc1
  v_mfma_f32_32x32x8bf16_1k v[128:143], v[8:9], v[4:5], v[128:143]
  v_exp_f32 v112, v112
  v_exp_f32 v113, v113
  v_exp_f32 v114, v114
  v_exp_f32 v115, v115
  v_exp_f32 v116, v116
  v_exp_f32 v117, v117
  v_exp_f32 v118, v118
  v_exp_f32 v119, v119
  s_mov_b64 exec, s[72:73]
  ds_read_b128 v[48:51], v3 offset:12800
  s_mov_b64 exec, -1
  s_waitcnt lgkmcnt(3)
  v_mfma_f32_32x32x16_bf16 v[64:79], v[52:55], v[104:107], v[64:79]
  v_cvt_pk_bf16_f32 v112, v112, v113
  v_cvt_pk_bf16_f32 v113, v114, v115
  v_cvt_pk_bf16_f32 v114, v116, v117
  v_cvt_pk_bf16_f32 v115, v118, v119
  s_mov_b32 s39, 16903168
  buffer_load_dwordx4 v[104:107], v11, s[20:23], s39 offen sc1
  s_mov_b32 s39, 16904192
  buffer_load_dwordx4 v[116:119], v11, s[20:23], s39 offen sc1
  v_exp_f32 v120, v120
  v_exp_f32 v121, v121
  v_exp_f32 v122, v122
  v_exp_f32 v123, v123
  v_exp_f32 v124, v124
  v_exp_f32 v125, v125
  v_exp_f32 v126, v126
  v_exp_f32 v127, v127
  s_mov_b64 exec, s[72:73]
  ds_read_b128 v[52:55], v3 offset:14080
  s_mov_b64 exec, -1
  s_waitcnt lgkmcnt(3)
  v_mfma_f32_32x32x16_bf16 v[64:79], v[56:59], v[112:115], v[64:79]
  v_cvt_pk_bf16_f32 v120, v120, v121
  v_cvt_pk_bf16_f32 v121, v122, v123
  v_cvt_pk_bf16_f32 v122, v124, v125
  v_cvt_pk_bf16_f32 v123, v126, v127
  s_mov_b32 s39, 16941056
  buffer_load_dwordx4 v[112:115], v11, s[20:23], s39 offen sc1
  s_mov_b32 s39, 16942080
  buffer_load_dwordx4 v[124:127], v11, s[20:23], s39 offen sc1
  v_mfma_f32_32x32x8bf16_1k v[144:159], v[8:9], v[4:5], v[144:159]
  v_exp_f32 v128, v128
  v_exp_f32 v129, v129
  v_exp_f32 v130, v130
  v_exp_f32 v131, v131
  v_exp_f32 v132, v132
  v_exp_f32 v133, v133
  v_exp_f32 v134, v134
  v_exp_f32 v135, v135
  s_mov_b64 exec, s[72:73]
  ds_read_b128 v[56:59], v3 offset:17920
  s_mov_b64 exec, -1
  s_waitcnt lgkmcnt(3)
  v_mfma_f32_32x32x16_bf16 v[64:79], v[60:63], v[120:123], v[64:79]
  v_cvt_pk_bf16_f32 v128, v128, v129
  v_cvt_pk_bf16_f32 v129, v130, v131
  v_cvt_pk_bf16_f32 v130, v132, v133
  v_cvt_pk_bf16_f32 v131, v134, v135
  s_mov_b32 s39, 16943104
  buffer_load_dwordx4 v[120:123], v11, s[20:23], s39 offen sc1
  s_mov_b32 s39, 16944128
  buffer_load_dwordx4 v[132:135], v11, s[20:23], s39 offen sc1
  v_exp_f32 v136, v136
  v_exp_f32 v137, v137
  v_exp_f32 v138, v138
  v_exp_f32 v139, v139
  v_exp_f32 v140, v140
  v_exp_f32 v141, v141
  v_exp_f32 v142, v142
  v_exp_f32 v143, v143
  s_mov_b64 exec, s[72:73]
  ds_read_b128 v[60:63], v3 offset:19200
  s_mov_b64 exec, -1
  s_waitcnt lgkmcnt(3)
  v_mfma_f32_32x32x16_bf16 v[64:79], v[48:51], v[128:131], v[64:79]
  v_cvt_pk_bf16_f32 v136, v136, v137
  v_cvt_pk_bf16_f32 v137, v138, v139
  v_cvt_pk_bf16_f32 v138, v140, v141
  v_cvt_pk_bf16_f32 v139, v142, v143
  s_mov_b32 s39, 16945152
  buffer_load_dwordx4 v[128:131], v11, s[20:23], s39 offen sc1
  v_mfma_f32_32x32x8bf16_1k v[160:175], v[8:9], v[4:5], v[160:175]
  v_exp_f32 v144, v144
  v_exp_f32 v145, v145
  v_exp_f32 v146, v146
  v_exp_f32 v147, v147
  v_exp_f32 v148, v148
  v_exp_f32 v149, v149
  v_exp_f32 v150, v150
  v_exp_f32 v151, v151
  s_mov_b64 exec, s[72:73]
  ds_read_b128 v[48:51], v3 offset:23040
  s_mov_b64 exec, -1
  s_waitcnt lgkmcnt(3)
  v_mfma_f32_32x32x16_bf16 v[64:79], v[52:55], v[136:139], v[64:79]
  v_cvt_pk_bf16_f32 v144, v144, v145
  v_cvt_pk_bf16_f32 v145, v146, v147
  v_cvt_pk_bf16_f32 v146, v148, v149
  v_cvt_pk_bf16_f32 v147, v150, v151
  buffer_load_dword v19, v7, s[20:23], 0 offen sc1
  v_exp_f32 v152, v152
  v_exp_f32 v153, v153
  v_exp_f32 v154, v154
  v_exp_f32 v155, v155
  v_exp_f32 v156, v156
  v_exp_f32 v157, v157
  v_exp_f32 v158, v158
  v_exp_f32 v159, v159
  s_mov_b64 exec, s[72:73]
  ds_read_b128 v[52:55], v3 offset:24320
  s_mov_b64 exec, -1
  s_waitcnt lgkmcnt(3)
  v_mfma_f32_32x32x16_bf16 v[64:79], v[56:59], v[144:147], v[64:79]
  v_cvt_pk_bf16_f32 v152, v152, v153
  v_cvt_pk_bf16_f32 v153, v154, v155
  v_cvt_pk_bf16_f32 v154, v156, v157
  v_cvt_pk_bf16_f32 v155, v158, v159
  v_mfma_f32_32x32x8bf16_1k v[176:191], v[8:9], v[4:5], v[176:191]
  v_exp_f32 v160, v160
  v_exp_f32 v161, v161
  v_exp_f32 v162, v162
  v_exp_f32 v163, v163
  v_exp_f32 v164, v164
  v_exp_f32 v165, v165
  v_exp_f32 v166, v166
  v_exp_f32 v167, v167
  s_mov_b64 exec, s[72:73]
  ds_read_b128 v[56:59], v3 offset:28160
  s_mov_b64 exec, -1
  s_waitcnt lgkmcnt(3)
  v_mfma_f32_32x32x16_bf16 v[64:79], v[60:63], v[152:155], v[64:79]
  v_cvt_pk_bf16_f32 v160, v160, v161
  v_cvt_pk_bf16_f32 v161, v162, v163
  v_cvt_pk_bf16_f32 v162, v164, v165
  v_cvt_pk_bf16_f32 v163, v166, v167
  v_exp_f32 v168, v168
  v_exp_f32 v169, v169
  v_exp_f32 v170, v170
  v_exp_f32 v171, v171
  v_exp_f32 v172, v172
  v_exp_f32 v173, v173
  v_exp_f32 v174, v174
  v_exp_f32 v175, v175
  s_mov_b64 exec, s[72:73]
  ds_read_b128 v[60:63], v3 offset:29440
  s_mov_b64 exec, -1
  s_waitcnt lgkmcnt(3)
  v_mfma_f32_32x32x16_bf16 v[64:79], v[48:51], v[160:163], v[64:79]
  v_cvt_pk_bf16_f32 v168, v168, v169
  v_cvt_pk_bf16_f32 v169, v170, v171
  v_cvt_pk_bf16_f32 v170, v172, v173
  v_cvt_pk_bf16_f32 v171, v174, v175
  v_mfma_f32_32x32x8bf16_1k v[192:207], v[8:9], v[4:5], v[192:207]
  v_exp_f32 v176, v176
  v_exp_f32 v177, v177
  v_exp_f32 v178, v178
  v_exp_f32 v179, v179
  v_exp_f32 v180, v180
  v_exp_f32 v181, v181
  v_exp_f32 v182, v182
  v_exp_f32 v183, v183
  s_mov_b64 exec, s[72:73]
  ds_read_b128 v[48:51], v3 offset:33280
  s_mov_b64 exec, -1
  s_waitcnt lgkmcnt(3)
  v_mfma_f32_32x32x16_bf16 v[64:79], v[52:55], v[168:171], v[64:79]
  v_cvt_pk_bf16_f32 v176, v176, v177
  v_cvt_pk_bf16_f32 v177, v178, v179
  v_cvt_pk_bf16_f32 v178, v180, v181
  v_cvt_pk_bf16_f32 v179, v182, v183
  v_exp_f32 v184, v184
  v_exp_f32 v185, v185
  v_exp_f32 v186, v186
  v_exp_f32 v187, v187
  v_exp_f32 v188, v188
  v_exp_f32 v189, v189
  v_exp_f32 v190, v190
  v_exp_f32 v191, v191
  s_mov_b64 exec, s[72:73]
  ds_read_b128 v[52:55], v3 offset:34560
  s_mov_b64 exec, -1
  s_waitcnt lgkmcnt(3)
  v_mfma_f32_32x32x16_bf16 v[64:79], v[56:59], v[176:179], v[64:79]
  v_cvt_pk_bf16_f32 v184, v184, v185
  v_cvt_pk_bf16_f32 v185, v186, v187
  v_cvt_pk_bf16_f32 v186, v188, v189
  v_cvt_pk_bf16_f32 v187, v190, v191
  s_waitcnt vmcnt(0)
  v_subrev_u32 v19, s3, v19
  v_subrev_u32 v19, 2, v19
  v_cmp_lt_u32 vcc, 1, v19
  s_cmp_lg_u64 vcc, 0
  s_cselect_b32 s68, 1, 0
  s_cselect_b32 s38, 117440512, 0
  v_add_u32 v13, s38, v13
  s_mov_b32 s39, 7864320
  buffer_load_dwordx4 v[140:143], v13, s[20:23], s39 offen sc1
  s_mov_b32 s39, 7933952
  buffer_load_dwordx4 v[136:139], v13, s[20:23], s39 offen sc1
  v_mfma_f32_32x32x8bf16_1k v[208:223], v[8:9], v[4:5], v[208:223]
  v_exp_f32 v192, v192
  v_exp_f32 v193, v193
  v_exp_f32 v194, v194
  v_exp_f32 v195, v195
  v_exp_f32 v196, v196
  v_exp_f32 v197, v197
  v_exp_f32 v198, v198
  v_exp_f32 v199, v199
  s_mov_b64 exec, s[72:73]
  ds_read_b128 v[56:59], v3 offset:38400
  s_mov_b64 exec, -1
  s_waitcnt lgkmcnt(3)
  v_mfma_f32_32x32x16_bf16 v[64:79], v[60:63], v[184:187], v[64:79]
  v_cvt_pk_bf16_f32 v192, v192, v193
  v_cvt_pk_bf16_f32 v193, v194, v195
  v_cvt_pk_bf16_f32 v194, v196, v197
  v_cvt_pk_bf16_f32 v195, v198, v199
  s_mov_b32 s39, 8003584
  buffer_load_dwordx4 v[148:151], v13, s[20:23], s39 offen sc1
  s_mov_b32 s39, 8073216
  buffer_load_dwordx4 v[144:147], v13, s[20:23], s39 offen sc1
  v_exp_f32 v200, v200
  v_exp_f32 v201, v201
  v_exp_f32 v202, v202
  v_exp_f32 v203, v203
  v_exp_f32 v204, v204
  v_exp_f32 v205, v205
  v_exp_f32 v206, v206
  v_exp_f32 v207, v207
  s_mov_b64 exec, s[72:73]
  ds_read_b128 v[60:63], v3 offset:39680
  s_mov_b64 exec, -1
  s_waitcnt lgkmcnt(3)
  v_mfma_f32_32x32x16_bf16 v[64:79], v[48:51], v[192:195], v[64:79]
  v_cvt_pk_bf16_f32 v200, v200, v201
  v_cvt_pk_bf16_f32 v201, v202, v203
  v_cvt_pk_bf16_f32 v202, v204, v205
  v_cvt_pk_bf16_f32 v203, v206, v207
  s_mov_b32 s39, 7872512
  buffer_load_dwordx4 v[156:159], v13, s[20:23], s39 offen sc1
  s_mov_b32 s39, 7942144
  buffer_load_dwordx4 v[152:155], v13, s[20:23], s39 offen sc1
  v_mfma_f32_32x32x8bf16_1k v[224:239], v[8:9], v[4:5], v[224:239]
  v_exp_f32 v208, v208
  v_exp_f32 v209, v209
  v_exp_f32 v210, v210
  v_exp_f32 v211, v211
  v_exp_f32 v212, v212
  v_exp_f32 v213, v213
  v_exp_f32 v214, v214
  v_exp_f32 v215, v215
  s_mov_b64 exec, s[72:73]
  ds_read_b128 v[48:51], v3 offset:43520
  s_mov_b64 exec, -1
  s_waitcnt lgkmcnt(3)
  v_mfma_f32_32x32x16_bf16 v[64:79], v[52:55], v[200:203], v[64:79]
  v_cvt_pk_bf16_f32 v208, v208, v209
  v_cvt_pk_bf16_f32 v209, v210, v211
  v_cvt_pk_bf16_f32 v210, v212, v213
  v_cvt_pk_bf16_f32 v211, v214, v215
  s_mov_b32 s39, 8011776
  buffer_load_dwordx4 v[164:167], v13, s[20:23], s39 offen sc1
  s_mov_b32 s39, 8081408
  buffer_load_dwordx4 v[160:163], v13, s[20:23], s39 offen sc1
  v_exp_f32 v216, v216
  v_exp_f32 v217, v217
  v_exp_f32 v218, v218
  v_exp_f32 v219, v219
  v_exp_f32 v220, v220
  v_exp_f32 v221, v221
  v_exp_f32 v222, v222
  v_exp_f32 v223, v223
  s_mov_b64 exec, s[72:73]
  ds_read_b128 v[52:55], v3 offset:44800
  s_mov_b64 exec, -1
  s_waitcnt lgkmcnt(3)
  v_mfma_f32_32x32x16_bf16 v[64:79], v[56:59], v[208:211], v[64:79]
  v_cvt_pk_bf16_f32 v216, v216, v217
  v_cvt_pk_bf16_f32 v217, v218, v219
  v_cvt_pk_bf16_f32 v218, v220, v221
  v_cvt_pk_bf16_f32 v219, v222, v223
  s_mov_b32 s39, 7880704
  buffer_load_dwordx4 v[172:175], v13, s[20:23], s39 offen sc1
  s_mov_b32 s39, 7950336
  buffer_load_dwordx4 v[168:171], v13, s[20:23], s39 offen sc1
  v_exp_f32 v224, v224
  v_exp_f32 v225, v225
  v_exp_f32 v226, v226
  v_exp_f32 v227, v227
  v_exp_f32 v228, v228
  v_exp_f32 v229, v229
  v_exp_f32 v230, v230
  v_exp_f32 v231, v231
  s_waitcnt lgkmcnt(2)
  v_mfma_f32_32x32x16_bf16 v[64:79], v[60:63], v[216:219], v[64:79]
  v_cvt_pk_bf16_f32 v224, v224, v225
  v_cvt_pk_bf16_f32 v225, v226, v227
  v_cvt_pk_bf16_f32 v226, v228, v229
  v_cvt_pk_bf16_f32 v227, v230, v231
  s_mov_b32 s39, 8019968
  buffer_load_dwordx4 v[180:183], v13, s[20:23], s39 offen sc1
  s_mov_b32 s39, 8089600
  buffer_load_dwordx4 v[176:179], v13, s[20:23], s39 offen sc1
  v_exp_f32 v232, v232
  v_exp_f32 v233, v233
  v_exp_f32 v234, v234
  v_exp_f32 v235, v235
  v_exp_f32 v236, v236
  v_exp_f32 v237, v237
  v_exp_f32 v238, v238
  v_exp_f32 v239, v239
  s_waitcnt lgkmcnt(1)
  v_mfma_f32_32x32x16_bf16 v[64:79], v[48:51], v[224:227], v[64:79]
  v_cvt_pk_bf16_f32 v232, v232, v233
  v_cvt_pk_bf16_f32 v233, v234, v235
  v_cvt_pk_bf16_f32 v234, v236, v237
  v_cvt_pk_bf16_f32 v235, v238, v239
  s_waitcnt lgkmcnt(0)
  s_nop 0
  v_mfma_f32_32x32x16_bf16 v[64:79], v[52:55], v[232:235], v[64:79]
  v_bfe_u32 v8, v0, 4, 1
  v_mul_u32_u24 v8, 69632, v8
  v_and_b32 v9, 15, v0
  v_lshl_add_u32 v8, v9, 4, v8
  v_lshrrev_b32 v9, 5, v0
  v_lshl_add_u32 v9, v9, 8, v8
  s_lshl_b32 s41, s32, 2
  s_add_u32 s41, s41, s35
  s_mul_i32 s41, s41, 139264
  s_mul_i32 s42, s33, 1280
  s_add_u32 s41, s41, s42
  s_add_u32 s41, s41, 7913472
  s_mul_i32 s42, s36, 768
  s_add_u32 s42, s42, s41
  s_lshl_b32 s43, s36, 3
  s_add_u32 s41, s41, s43
  s_nop 3
  v_rcp_f32 v4, v76
  s_nop 0
  v_mul_f32 v64, v64, v4
  v_mul_f32 v65, v65, v4
  v_mul_f32 v66, v66, v4
  v_mul_f32 v67, v67, v4
  v_mul_f32 v68, v68, v4
  v_mul_f32 v69, v69, v4
  v_mul_f32 v70, v70, v4
  v_mul_f32 v71, v71, v4
  v_mul_f32 v72, v72, v4
  v_mul_f32 v73, v73, v4
  v_mul_f32 v74, v74, v4
  v_mul_f32 v75, v75, v4
  v_cvt_pk_bf16_f32 v64, v64, v65
  v_cvt_pk_bf16_f32 v65, v66, v67
  v_cvt_pk_bf16_f32 v66, v68, v69
  v_cvt_pk_bf16_f32 v67, v70, v71
  v_cvt_pk_bf16_f32 v68, v72, v73
  v_cvt_pk_bf16_f32 v69, v74, v75
  v_min_u32 v64, -2, v64
  v_min_u32 v65, -2, v65
  v_min_u32 v66, -2, v66
  v_min_u32 v67, -2, v67
  v_min_u32 v68, -2, v68
  v_min_u32 v69, -2, v69
  buffer_store_dwordx4 v[64:67], v9, s[20:23], s42 offen sc1
  s_mov_b32 exec_hi, 0
  buffer_store_dwordx2 v[68:69], v8, s[20:23], s41 offen offset:512 sc1
  s_mov_b64 exec, -1
  s_cmp_lg_u32 s68, 0
  s_cbranch_scc1 LT_20
RT_21:
  v_lshl_add_u32 v7, v0, 4, s69
  v_lshl_add_u32 v19, v0, 4, s70
  s_setprio 0
  s_waitcnt vmcnt(10)
  v_mfma_f32_16x16x32_bf16 v[196:199], v[80:83], v[140:143], 0
  v_mfma_f32_16x16x32_bf16 v[192:195], v[84:87], v[140:143], 0
  v_mfma_f32_16x16x32_bf16 v[204:207], v[88:91], v[140:143], 0
  v_mfma_f32_16x16x32_bf16 v[200:203], v[92:95], v[140:143], 0
  v_mfma_f32_16x16x32_bf16 v[212:215], v[240:243], v[140:143], 0
  s_mov_b32 s39, 7888896
  buffer_load_dwordx4 v[140:143], v13, s[20:23], s39 offen sc1
  v_mfma_f32_16x16x32_bf16 v[208:211], v[80:83], v[136:139], 0
  v_mfma_f32_16x16x32_bf16 v[220:223], v[84:87], v[136:139], 0
  v_mfma_f32_16x16x32_bf16 v[216:219], v[88:91], v[136:139], 0
  v_mfma_f32_16x16x32_bf16 v[228:231], v[92:95], v[136:139], 0
  v_mfma_f32_16x16x32_bf16 v[224:227], v[240:243], v[136:139], 0
  s_mov_b32 s39, 7958528
  buffer_load_dwordx4 v[136:139], v13, s[20:23], s39 offen sc1
  v_mfma_f32_16x16x32_bf16 v[236:239], v[80:83], v[148:151], 0
  v_mfma_f32_16x16x32_bf16 v[232:235], v[84:87], v[148:151], 0
  v_mfma_f32_16x16x32_bf16 v[48:51], v[88:91], v[148:151], 0
  v_mfma_f32_16x16x32_bf16 v[52:55], v[92:95], v[148:151], 0
  v_mfma_f32_16x16x32_bf16 v[56:59], v[240:243], v[148:151], 0
  s_mov_b32 s39, 8028160
  buffer_load_dwordx4 v[148:151], v13, s[20:23], s39 offen sc1
  v_mfma_f32_16x16x32_bf16 v[60:63], v[80:83], v[144:147], 0
  v_mfma_f32_16x16x32_bf16 v[64:67], v[84:87], v[144:147], 0
  v_mfma_f32_16x16x32_bf16 v[68:71], v[88:91], v[144:147], 0
  v_mfma_f32_16x16x32_bf16 v[72:75], v[92:95], v[144:147], 0
  v_mfma_f32_16x16x32_bf16 v[76:79], v[240:243], v[144:147], 0
  s_mov_b32 s39, 8097792
  buffer_load_dwordx4 v[144:147], v13, s[20:23], s39 offen sc1
  s_waitcnt vmcnt(10)
  v_mfma_f32_16x16x32_bf16 v[196:199], v[244:247], v[156:159], v[196:199]
  v_mfma_f32_16x16x32_bf16 v[192:195], v[248:251], v[156:159], v[192:195]
  ds_read_b128 v[240:243], v19 offset:0
  v_mfma_f32_16x16x32_bf16 v[204:207], v[252:255], v[156:159], v[204:207]
  v_mfma_f32_16x16x32_bf16 v[200:203], v[20:23], v[156:159], v[200:203]
  ds_read_b128 v[92:95], v7 offset:3072
  v_mfma_f32_16x16x32_bf16 v[212:215], v[24:27], v[156:159], v[212:215]
  s_mov_b32 s39, 7897088
  buffer_load_dwordx4 v[156:159], v13, s[20:23], s39 offen sc1
  v_mfma_f32_16x16x32_bf16 v[208:211], v[244:247], v[152:155], v[208:211]
  ds_read_b128 v[88:91], v7 offset:2048
  v_mfma_f32_16x16x32_bf16 v[220:223], v[248:251], v[152:155], v[220:223]
  v_mfma_f32_16x16x32_bf16 v[216:219], v[252:255], v[152:155], v[216:219]
  ds_read_b128 v[84:87], v7 offset:1024
  v_mfma_f32_16x16x32_bf16 v[228:231], v[20:23], v[152:155], v[228:231]
  v_mfma_f32_16x16x32_bf16 v[224:227], v[24:27], v[152:155], v[224:227]
  s_mov_b32 s39, 7966720
  buffer_load_dwordx4 v[152:155], v13, s[20:23], s39 offen sc1
  v_mfma_f32_16x16x32_bf16 v[236:239], v[244:247], v[164:167], v[236:239]
  v_mfma_f32_16x16x32_bf16 v[232:235], v[248:251], v[164:167], v[232:235]
  ds_read_b128 v[80:83], v7 offset:0
  v_mfma_f32_16x16x32_bf16 v[48:51], v[252:255], v[164:167], v[48:51]
  v_mfma_f32_16x16x32_bf16 v[52:55], v[20:23], v[164:167], v[52:55]
  v_mfma_f32_16x16x32_bf16 v[56:59], v[24:27], v[164:167], v[56:59]
  s_mov_b32 s39, 8036352
  buffer_load_dwordx4 v[164:167], v13, s[20:23], s39 offen sc1
  v_mfma_f32_16x16x32_bf16 v[60:63], v[244:247], v[160:163], v[60:63]
  v_mfma_f32_16x16x32_bf16 v[64:67], v[248:251], v[160:163], v[64:67]
  v_mfma_f32_16x16x32_bf16 v[68:71], v[252:255], v[160:163], v[68:71]
  v_mfma_f32_16x16x32_bf16 v[72:75], v[20:23], v[160:163], v[72:75]
  v_mfma_f32_16x16x32_bf16 v[76:79], v[24:27], v[160:163], v[76:79]
  s_mov_b32 s39, 8105984
  buffer_load_dwordx4 v[160:163], v13, s[20:23], s39 offen sc1
  s_waitcnt vmcnt(10)
  v_mfma_f32_16x16x32_bf16 v[196:199], v[28:31], v[172:175], v[196:199]
  v_mfma_f32_16x16x32_bf16 v[192:195], v[32:35], v[172:175], v[192:195]
  ds_read_b128 v[24:27], v19 offset:5120
  v_mfma_f32_16x16x32_bf16 v[204:207], v[36:39], v[172:175], v[204:207]
  v_mfma_f32_16x16x32_bf16 v[200:203], v[40:43], v[172:175], v[200:203]
  ds_read_b128 v[20:23], v19 offset:4096
  v_mfma_f32_16x16x32_bf16 v[212:215], v[44:47], v[172:175], v[212:215]
  s_mov_b32 s39, 7905280
  buffer_load_dwordx4 v[172:175], v13, s[20:23], s39 offen sc1
  v_mfma_f32_16x16x32_bf16 v[208:211], v[28:31], v[168:171], v[208:211]
  ds_read_b128 v[252:255], v19 offset:3072
  v_mfma_f32_16x16x32_bf16 v[220:223], v[32:35], v[168:171], v[220:223]
  v_mfma_f32_16x16x32_bf16 v[216:219], v[36:39], v[168:171], v[216:219]
  ds_read_b128 v[248:251], v19 offset:2048
  v_mfma_f32_16x16x32_bf16 v[228:231], v[40:43], v[168:171], v[228:231]
  v_mfma_f32_16x16x32_bf16 v[224:227], v[44:47], v[168:171], v[224:227]
  s_mov_b32 s39, 7974912
  buffer_load_dwordx4 v[168:171], v13, s[20:23], s39 offen sc1
  v_mfma_f32_16x16x32_bf16 v[236:239], v[28:31], v[180:183], v[236:239]
  v_mfma_f32_16x16x32_bf16 v[232:235], v[32:35], v[180:183], v[232:235]
  ds_read_b128 v[244:247], v19 offset:1024
  v_mfma_f32_16x16x32_bf16 v[48:51], v[36:39], v[180:183], v[48:51]
  v_mfma_f32_16x16x32_bf16 v[52:55], v[40:43], v[180:183], v[52:55]
  v_mfma_f32_16x16x32_bf16 v[56:59], v[44:47], v[180:183], v[56:59]
  s_mov_b32 s39, 8044544
  buffer_load_dwordx4 v[180:183], v13, s[20:23], s39 offen sc1
  v_mfma_f32_16x16x32_bf16 v[60:63], v[28:31], v[176:179], v[60:63]
  v_mfma_f32_16x16x32_bf16 v[64:67], v[32:35], v[176:179], v[64:67]
  v_mfma_f32_16x16x32_bf16 v[68:71], v[36:39], v[176:179], v[68:71]
  v_mfma_f32_16x16x32_bf16 v[72:75], v[40:43], v[176:179], v[72:75]
  v_mfma_f32_16x16x32_bf16 v[76:79], v[44:47], v[176:179], v[76:79]
  s_mov_b32 s39, 8114176
  buffer_load_dwordx4 v[176:179], v13, s[20:23], s39 offen sc1
  s_cmp_ge_u32 s34, 4
  s_cbranch_scc0 L_24
  s_barrier
L_24:
  s_waitcnt vmcnt(8)
  v_mfma_f32_16x16x32_bf16 v[196:199], v[100:103], v[140:143], v[196:199]
  v_mfma_f32_16x16x32_bf16 v[192:195], v[96:99], v[140:143], v[192:195]
  s_mov_b32 s39, 17068032
  buffer_load_dwordx4 v[44:47], v11, s[20:23], s39 offen sc1
  v_mfma_f32_16x16x32_bf16 v[204:207], v[108:111], v[140:143], v[204:207]
  v_mfma_f32_16x16x32_bf16 v[200:203], v[104:107], v[140:143], v[200:203]
  s_mov_b32 s39, 17067008
  buffer_load_dwordx4 v[40:43], v11, s[20:23], s39 offen sc1
  v_mfma_f32_16x16x32_bf16 v[212:215], v[116:119], v[140:143], v[212:215]
  v_mfma_f32_16x16x32_bf16 v[208:211], v[100:103], v[136:139], v[208:211]
  s_mov_b32 s39, 17065984
  buffer_load_dwordx4 v[36:39], v11, s[20:23], s39 offen sc1
  v_mfma_f32_16x16x32_bf16 v[220:223], v[96:99], v[136:139], v[220:223]
  v_mfma_f32_16x16x32_bf16 v[216:219], v[108:111], v[136:139], v[216:219]
  ds_read_b128 v[32:35], v19 offset:7168
  v_mfma_f32_16x16x32_bf16 v[228:231], v[104:107], v[136:139], v[228:231]
  v_mfma_f32_16x16x32_bf16 v[224:227], v[116:119], v[136:139], v[224:227]
  ds_read_b128 v[28:31], v19 offset:6144
  v_mfma_f32_16x16x32_bf16 v[236:239], v[100:103], v[148:151], v[236:239]
  v_mfma_f32_16x16x32_bf16 v[232:235], v[96:99], v[148:151], v[232:235]
  v_mfma_f32_16x16x32_bf16 v[48:51], v[108:111], v[148:151], v[48:51]
  v_mfma_f32_16x16x32_bf16 v[52:55], v[104:107], v[148:151], v[52:55]
  v_mfma_f32_16x16x32_bf16 v[56:59], v[116:119], v[148:151], v[56:59]
  v_mfma_f32_16x16x32_bf16 v[60:63], v[100:103], v[144:147], v[60:63]
  v_mfma_f32_16x16x32_bf16 v[64:67], v[96:99], v[144:147], v[64:67]
  v_mfma_f32_16x16x32_bf16 v[68:71], v[108:111], v[144:147], v[68:71]
  v_mfma_f32_16x16x32_bf16 v[72:75], v[104:107], v[144:147], v[72:75]
  v_mfma_f32_16x16x32_bf16 v[76:79], v[116:119], v[144:147], v[76:79]
  s_cmp_ge_u32 s34, 4
  s_cbranch_scc1 L_25
  s_mov_b32 s39, 17104896
  buffer_load_dwordx4 v[100:103], v11, s[20:23], s39 offen sc1
  s_mov_b32 s39, 17105920
  buffer_load_dwordx4 v[96:99], v11, s[20:23], s39 offen sc1
  s_mov_b32 s39, 17106944
  buffer_load_dwordx4 v[108:111], v11, s[20:23], s39 offen sc1
  s_mov_b32 s39, 17107968
  buffer_load_dwordx4 v[104:107], v11, s[20:23], s39 offen sc1
  s_mov_b32 s39, 17108992
  buffer_load_dwordx4 v[116:119], v11, s[20:23], s39 offen sc1
L_25:
  s_waitcnt lgkmcnt(0)
  s_cmp_ge_u32 s34, 4
  s_cbranch_scc1 L_26
  s_barrier
L_26:
  s_mov_b32 s39, 7913472
  buffer_load_dwordx4 v[140:143], v13, s[20:23], s39 offen sc1
  s_mov_b32 s39, 7983104
  buffer_load_dwordx4 v[136:139], v13, s[20:23], s39 offen sc1
  s_mov_b32 s39, 8052736
  buffer_load_dwordx4 v[148:151], v13, s[20:23], s39 offen sc1
  s_mov_b32 s39, 8122368
  buffer_load_dwordx4 v[144:147], v13, s[20:23], s39 offen sc1
  s_waitcnt vmcnt(11)
  v_mfma_f32_16x16x32_bf16 v[196:199], v[112:115], v[156:159], v[196:199]
  v_mfma_f32_16x16x32_bf16 v[192:195], v[124:127], v[156:159], v[192:195]
  v_mfma_f32_16x16x32_bf16 v[204:207], v[120:123], v[156:159], v[204:207]
  v_mfma_f32_16x16x32_bf16 v[200:203], v[132:135], v[156:159], v[200:203]
  v_mfma_f32_16x16x32_bf16 v[212:215], v[128:131], v[156:159], v[212:215]
  v_mfma_f32_16x16x32_bf16 v[208:211], v[112:115], v[152:155], v[208:211]
  v_mfma_f32_16x16x32_bf16 v[220:223], v[124:127], v[152:155], v[220:223]
  v_mfma_f32_16x16x32_bf16 v[216:219], v[120:123], v[152:155], v[216:219]
  v_mfma_f32_16x16x32_bf16 v[228:231], v[132:135], v[152:155], v[228:231]
  v_mfma_f32_16x16x32_bf16 v[224:227], v[128:131], v[152:155], v[224:227]
  v_mfma_f32_16x16x32_bf16 v[236:239], v[112:115], v[164:167], v[236:239]
  v_mfma_f32_16x16x32_bf16 v[232:235], v[124:127], v[164:167], v[232:235]
  v_mfma_f32_16x16x32_bf16 v[48:51], v[120:123], v[164:167], v[48:51]
  v_mfma_f32_16x16x32_bf16 v[52:55], v[132:135], v[164:167], v[52:55]
  v_mfma_f32_16x16x32_bf16 v[56:59], v[128:131], v[164:167], v[56:59]
  v_mfma_f32_16x16x32_bf16 v[60:63], v[112:115], v[160:163], v[60:63]
  v_mfma_f32_16x16x32_bf16 v[64:67], v[124:127], v[160:163], v[64:67]
  v_mfma_f32_16x16x32_bf16 v[68:71], v[120:123], v[160:163], v[68:71]
  v_mfma_f32_16x16x32_bf16 v[72:75], v[132:135], v[160:163], v[72:75]
  v_mfma_f32_16x16x32_bf16 v[76:79], v[128:131], v[160:163], v[76:79]
  v_and_b32 v14, 15, v0
  v_mul_u32_u24 v14, 1280, v14
  v_lshrrev_b32 v15, 4, v0
  v_lshl_add_u32 v14, v15, 3, v14
  s_mul_i32 s40, s44, 81920
  s_mul_i32 s41, s45, 160
  s_add_u32 s40, s40, s41
  s_add_u32 s41, s34, 0
  s_min_u32 s41, s41, 19
  s_mul_i32 s42, s41, 205
  s_lshr_b32 s42, s42, 10
  s_mul_i32 s42, s42, 20320
  s_lshl_b32 s41, s41, 5
  s_add_u32 s41, s41, s42
  s_add_u32 s41, s41, s40
  v_add_u32 v16, s41, v14
  buffer_load_dwordx2 v[2:3], v16, s[4:7], 0 offen
  s_add_u32 s41, s34, 8
  s_min_u32 s41, s41, 19
  s_mul_i32 s42, s41, 205
  s_lshr_b32 s42, s42, 10
  s_mul_i32 s42, s42, 20320
  s_lshl_b32 s41, s41, 5
  s_add_u32 s41, s41, s42
  s_add_u32 s41, s41, s40
  v_add_u32 v17, s41, v14
  buffer_load_dwordx2 v[4:5], v17, s[4:7], 0 offen
  s_add_u32 s41, s34, 16
  s_min_u32 s41, s41, 19
  s_mul_i32 s42, s41, 205
  s_lshr_b32 s42, s42, 10
  s_mul_i32 s42, s42, 20320
  s_lshl_b32 s41, s41, 5
  s_add_u32 s41, s41, s42
  s_add_u32 s41, s41, s40
  v_add_u32 v18, s41, v14
  buffer_load_dwordx2 v[8:9], v18, s[4:7], 0 offen
  s_mul_i32 s38, s34, 20480
  v_lshl_add_u32 v15, v0, 4, s38
  s_lshl_b32 s38, s34, 10
  v_lshl_add_u32 v14, v0, 4, s38
  s_mov_b32 s39, 7921664
  buffer_load_dwordx4 v[156:159], v13, s[20:23], s39 offen sc1
  s_mov_b32 s39, 7991296
  buffer_load_dwordx4 v[152:155], v13, s[20:23], s39 offen sc1
  s_mov_b32 s39, 8060928
  buffer_load_dwordx4 v[164:167], v13, s[20:23], s39 offen sc1
  s_mov_b32 s39, 8130560
  buffer_load_dwordx4 v[160:163], v13, s[20:23], s39 offen sc1
  s_waitcnt vmcnt(14)
  v_mfma_f32_16x16x32_bf16 v[196:199], v[80:83], v[172:175], v[196:199]
  v_mfma_f32_16x16x32_bf16 v[192:195], v[84:87], v[172:175], v[192:195]
  v_mfma_f32_16x16x32_bf16 v[204:207], v[88:91], v[172:175], v[204:207]
  v_mfma_f32_16x16x32_bf16 v[200:203], v[92:95], v[172:175], v[200:203]
  v_mfma_f32_16x16x32_bf16 v[212:215], v[240:243], v[172:175], v[212:215]
  v_mfma_f32_16x16x32_bf16 v[208:211], v[80:83], v[168:171], v[208:211]
  v_mfma_f32_16x16x32_bf16 v[220:223], v[84:87], v[168:171], v[220:223]
  v_mfma_f32_16x16x32_bf16 v[216:219], v[88:91], v[168:171], v[216:219]
  v_mfma_f32_16x16x32_bf16 v[228:231], v[92:95], v[168:171], v[228:231]
  v_mfma_f32_16x16x32_bf16 v[224:227], v[240:243], v[168:171], v[224:227]
  v_mfma_f32_16x16x32_bf16 v[236:239], v[80:83], v[180:183], v[236:239]
  v_mfma_f32_16x16x32_bf16 v[232:235], v[84:87], v[180:183], v[232:235]
  v_mfma_f32_16x16x32_bf16 v[48:51], v[88:91], v[180:183], v[48:51]
  v_mfma_f32_16x16x32_bf16 v[52:55], v[92:95], v[180:183], v[52:55]
  v_mfma_f32_16x16x32_bf16 v[56:59], v[240:243], v[180:183], v[56:59]
  v_mfma_f32_16x16x32_bf16 v[60:63], v[80:83], v[176:179], v[60:63]
  v_mfma_f32_16x16x32_bf16 v[64:67], v[84:87], v[176:179], v[64:67]
  v_mfma_f32_16x16x32_bf16 v[68:71], v[88:91], v[176:179], v[68:71]
  v_mfma_f32_16x16x32_bf16 v[72:75], v[92:95], v[176:179], v[72:75]
  v_mfma_f32_16x16x32_bf16 v[76:79], v[240:243], v[176:179], v[76:79]
  s_waitcnt lgkmcnt(0)
  s_cmp_ge_u32 s34, 4
  s_cbranch_scc1 L_27
  s_mov_b32 s39, 7929856
  buffer_load_dwordx4 v[172:175], v13, s[20:23], s39 offen sc1
  s_mov_b32 s39, 7999488
  buffer_load_dwordx4 v[168:171], v13, s[20:23], s39 offen sc1
  s_mov_b32 s39, 8069120
  buffer_load_dwordx4 v[180:183], v13, s[20:23], s39 offen sc1
  s_mov_b32 s39, 8138752
  buffer_load_dwordx4 v[176:179], v13, s[20:23], s39 offen sc1
  s_waitcnt vmcnt(8)
  v_max3_u32 v19, v140, v141, v142
  v_max3_u32 v19, v143, v136, v19
  v_max3_u32 v19, v137, v138, v19
  v_max3_u32 v19, v139, v148, v19
  v_max3_u32 v19, v149, v150, v19
  v_max3_u32 v19, v151, v144, v19
  v_max3_u32 v19, v145, v146, v19
  v_max_u32 v19, v147, v19
  v_cmp_eq_u32 vcc, -1, v19
  s_cbranch_vccnz SP_29
RT_30:
  v_mfma_f32_16x16x32_bf16 v[196:199], v[244:247], v[140:143], v[196:199]
  v_mfma_f32_16x16x32_bf16 v[192:195], v[248:251], v[140:143], v[192:195]
  v_mfma_f32_16x16x32_bf16 v[204:207], v[252:255], v[140:143], v[204:207]
  v_mfma_f32_16x16x32_bf16 v[200:203], v[20:23], v[140:143], v[200:203]
  v_mfma_f32_16x16x32_bf16 v[212:215], v[24:27], v[140:143], v[212:215]
  v_mfma_f32_16x16x32_bf16 v[208:211], v[244:247], v[136:139], v[208:211]
  v_mfma_f32_16x16x32_bf16 v[220:223], v[248:251], v[136:139], v[220:223]
  v_mfma_f32_16x16x32_bf16 v[216:219], v[252:255], v[136:139], v[216:219]
  v_mfma_f32_16x16x32_bf16 v[228:231], v[20:23], v[136:139], v[228:231]
  v_mfma_f32_16x16x32_bf16 v[224:227], v[24:27], v[136:139], v[224:227]
  v_mfma_f32_16x16x32_bf16 v[236:239], v[244:247], v[148:151], v[236:239]
  v_mfma_f32_16x16x32_bf16 v[232:235], v[248:251], v[148:151], v[232:235]
  v_mfma_f32_16x16x32_bf16 v[48:51], v[252:255], v[148:151], v[48:51]
  v_mfma_f32_16x16x32_bf16 v[52:55], v[20:23], v[148:151], v[52:55]
  v_mfma_f32_16x16x32_bf16 v[56:59], v[24:27], v[148:151], v[56:59]
  v_mfma_f32_16x16x32_bf16 v[60:63], v[244:247], v[144:147], v[60:63]
  v_mfma_f32_16x16x32_bf16 v[64:67], v[248:251], v[144:147], v[64:67]
  v_mfma_f32_16x16x32_bf16 v[68:71], v[252:255], v[144:147], v[68:71]
  v_mfma_f32_16x16x32_bf16 v[72:75], v[20:23], v[144:147], v[72:75]
  v_mfma_f32_16x16x32_bf16 v[76:79], v[24:27], v[144:147], v[76:79]
  s_waitcnt vmcnt(4)
  v_max3_u32 v19, v156, v157, v158
  v_max3_u32 v19, v159, v152, v19
  v_max3_u32 v19, v153, v154, v19
  v_max3_u32 v19, v155, v164, v19
  v_max3_u32 v19, v165, v166, v19
  v_max3_u32 v19, v167, v160, v19
  v_max3_u32 v19, v161, v162, v19
  v_max_u32 v19, v163, v19
  v_cmp_eq_u32 vcc, -1, v19
  s_cbranch_vccnz SP_32
RT_33:
  v_mfma_f32_16x16x32_bf16 v[196:199], v[28:31], v[156:159], v[196:199]
  v_mfma_f32_16x16x32_bf16 v[192:195], v[32:35], v[156:159], v[192:195]
  v_mfma_f32_16x16x32_bf16 v[204:207], v[36:39], v[156:159], v[204:207]
  v_mfma_f32_16x16x32_bf16 v[200:203], v[40:43], v[156:159], v[200:203]
  v_mfma_f32_16x16x32_bf16 v[212:215], v[44:47], v[156:159], v[212:215]
  v_mfma_f32_16x16x32_bf16 v[208:211], v[28:31], v[152:155], v[208:211]
  v_mfma_f32_16x16x32_bf16 v[220:223], v[32:35], v[152:155], v[220:223]
  v_mfma_f32_16x16x32_bf16 v[216:219], v[36:39], v[152:155], v[216:219]
  v_mfma_f32_16x16x32_bf16 v[228:231], v[40:43], v[152:155], v[228:231]
  v_mfma_f32_16x16x32_bf16 v[224:227], v[44:47], v[152:155], v[224:227]
  v_mfma_f32_16x16x32_bf16 v[236:239], v[28:31], v[164:167], v[236:239]
  v_mfma_f32_16x16x32_bf16 v[232:235], v[32:35], v[164:167], v[232:235]
  v_mfma_f32_16x16x32_bf16 v[48:51], v[36:39], v[164:167], v[48:51]
  v_mfma_f32_16x16x32_bf16 v[52:55], v[40:43], v[164:167], v[52:55]
  v_mfma_f32_16x16x32_bf16 v[56:59], v[44:47], v[164:167], v[56:59]
  v_mfma_f32_16x16x32_bf16 v[60:63], v[28:31], v[160:163], v[60:63]
  v_mfma_f32_16x16x32_bf16 v[64:67], v[32:35], v[160:163], v[64:67]
  v_mfma_f32_16x16x32_bf16 v[68:71], v[36:39], v[160:163], v[68:71]
  v_mfma_f32_16x16x32_bf16 v[72:75], v[40:43], v[160:163], v[72:75]
  v_mfma_f32_16x16x32_bf16 v[76:79], v[44:47], v[160:163], v[76:79]
  s_waitcnt vmcnt(0)
  v_max3_u32 v19, v172, v173, v174
  v_max3_u32 v19, v175, v168, v19
  v_max3_u32 v19, v169, v170, v19
  v_max3_u32 v19, v171, v180, v19
  v_max3_u32 v19, v181, v182, v19
  v_max3_u32 v19, v183, v176, v19
  v_max3_u32 v19, v177, v178, v19
  v_max_u32 v19, v179, v19
  v_cmp_eq_u32 vcc, -1, v19
  s_cbranch_vccnz SP_35
RT_36:
  v_mfma_f32_16x16x32_bf16 v[196:199], v[100:103], v[172:175], v[196:199]
  v_mfma_f32_16x16x32_bf16 v[192:195], v[96:99], v[172:175], v[192:195]
  v_mfma_f32_16x16x32_bf16 v[204:207], v[108:111], v[172:175], v[204:207]
  v_mfma_f32_16x16x32_bf16 v[200:203], v[104:107], v[172:175], v[200:203]
  v_mfma_f32_16x16x32_bf16 v[212:215], v[116:119], v[172:175], v[212:215]
  v_mfma_f32_16x16x32_bf16 v[208:211], v[100:103], v[168:171], v[208:211]
  ds_write_b128 v15, v[196:199] offset:0
  v_mfma_f32_16x16x32_bf16 v[220:223], v[96:99], v[168:171], v[220:223]
  ds_write_b128 v15, v[192:195] offset:1024
  v_mfma_f32_16x16x32_bf16 v[216:219], v[108:111], v[168:171], v[216:219]
  ds_write_b128 v15, v[204:207] offset:2048
  v_mfma_f32_16x16x32_bf16 v[228:231], v[104:107], v[168:171], v[228:231]
  ds_write_b128 v15, v[200:203] offset:3072
  v_mfma_f32_16x16x32_bf16 v[224:227], v[116:119], v[168:171], v[224:227]
  ds_write_b128 v15, v[212:215] offset:4096
  v_mfma_f32_16x16x32_bf16 v[236:239], v[100:103], v[180:183], v[236:239]
  ds_write_b128 v15, v[208:211] offset:5120
  v_mfma_f32_16x16x32_bf16 v[232:235], v[96:99], v[180:183], v[232:235]
  ds_write_b128 v15, v[220:223] offset:6144
  v_mfma_f32_16x16x32_bf16 v[48:51], v[108:111], v[180:183], v[48:51]
  ds_write_b128 v15, v[216:219] offset:7168
  v_mfma_f32_16x16x32_bf16 v[52:55], v[104:107], v[180:183], v[52:55]
  ds_write_b128 v15, v[228:231] offset:8192
  v_mfma_f32_16x16x32_bf16 v[56:59], v[116:119], v[180:183], v[56:59]
  ds_write_b128 v15, v[224:227] offset:9216
  v_mfma_f32_16x16x32_bf16 v[60:63], v[100:103], v[176:179], v[60:63]
  ds_write_b128 v15, v[236:239] offset:10240
  v_mfma_f32_16x16x32_bf16 v[64:67], v[96:99], v[176:179], v[64:67]
  ds_write_b128 v15, v[232:235] offset:11264
  v_mfma_f32_16x16x32_bf16 v[68:71], v[108:111], v[176:179], v[68:71]
  ds_write_b128 v15, v[48:51] offset:12288
  v_mfma_f32_16x16x32_bf16 v[72:75], v[104:107], v[176:179], v[72:75]
  ds_write_b128 v15, v[52:55] offset:13312
  v_mfma_f32_16x16x32_bf16 v[76:79], v[116:119], v[176:179], v[76:79]
  ds_write_b128 v15, v[56:59] offset:14336
  s_nop 1
  ds_write_b128 v15, v[60:63] offset:15360
  ds_write_b128 v15, v[64:67] offset:16384
  ds_write_b128 v15, v[68:71] offset:17408
  s_nop 0
  ds_write_b128 v15, v[72:75] offset:18432
  s_nop 0
  ds_write_b128 v15, v[76:79] offset:19456
  s_branch L_28
L_27:
  s_waitcnt vmcnt(4)
  v_max3_u32 v19, v140, v141, v142
  v_max3_u32 v19, v143, v136, v19
  v_max3_u32 v19, v137, v138, v19
  v_max3_u32 v19, v139, v148, v19
  v_max3_u32 v19, v149, v150, v19
  v_max3_u32 v19, v151, v144, v19
  v_max3_u32 v19, v145, v146, v19
  v_max_u32 v19, v147, v19
  v_cmp_eq_u32 vcc, -1, v19
  s_cbranch_vccnz SP_38
RT_39:
  v_mfma_f32_16x16x32_bf16 v[196:199], v[244:247], v[140:143], v[196:199]
  v_mfma_f32_16x16x32_bf16 v[192:195], v[248:251], v[140:143], v[192:195]
  v_mfma_f32_16x16x32_bf16 v[204:207], v[252:255], v[140:143], v[204:207]
  v_mfma_f32_16x16x32_bf16 v[200:203], v[20:23], v[140:143], v[200:203]
  v_mfma_f32_16x16x32_bf16 v[212:215], v[24:27], v[140:143], v[212:215]
  v_mfma_f32_16x16x32_bf16 v[208:211], v[244:247], v[136:139], v[208:211]
  v_mfma_f32_16x16x32_bf16 v[220:223], v[248:251], v[136:139], v[220:223]
  v_mfma_f32_16x16x32_bf16 v[216:219], v[252:255], v[136:139], v[216:219]
  v_mfma_f32_16x16x32_bf16 v[228:231], v[20:23], v[136:139], v[228:231]
  v_mfma_f32_16x16x32_bf16 v[224:227], v[24:27], v[136:139], v[224:227]
  v_mfma_f32_16x16x32_bf16 v[236:239], v[244:247], v[148:151], v[236:239]
  v_mfma_f32_16x16x32_bf16 v[232:235], v[248:251], v[148:151], v[232:235]
  v_mfma_f32_16x16x32_bf16 v[48:51], v[252:255], v[148:151], v[48:51]
  v_mfma_f32_16x16x32_bf16 v[52:55], v[20:23], v[148:151], v[52:55]
  v_mfma_f32_16x16x32_bf16 v[56:59], v[24:27], v[148:151], v[56:59]
  v_mfma_f32_16x16x32_bf16 v[60:63], v[244:247], v[144:147], v[60:63]
  v_mfma_f32_16x16x32_bf16 v[64:67], v[248:251], v[144:147], v[64:67]
  v_mfma_f32_16x16x32_bf16 v[68:71], v[252:255], v[144:147], v[68:71]
  v_mfma_f32_16x16x32_bf16 v[72:75], v[20:23], v[144:147], v[72:75]
  v_mfma_f32_16x16x32_bf16 v[76:79], v[24:27], v[144:147], v[76:79]
  s_waitcnt vmcnt(0)
  v_max3_u32 v19, v156, v157, v158
  v_max3_u32 v19, v159, v152, v19
  v_max3_u32 v19, v153, v154, v19
  v_max3_u32 v19, v155, v164, v19
  v_max3_u32 v19, v165, v166, v19
  v_max3_u32 v19, v167, v160, v19
  v_max3_u32 v19, v161, v162, v19
  v_max_u32 v19, v163, v19
  v_cmp_eq_u32 vcc, -1, v19
  s_cbranch_vccnz SP_41
RT_42:
  v_mfma_f32_16x16x32_bf16 v[196:199], v[28:31], v[156:159], v[196:199]
  v_mfma_f32_16x16x32_bf16 v[192:195], v[32:35], v[156:159], v[192:195]
  v_mfma_f32_16x16x32_bf16 v[204:207], v[36:39], v[156:159], v[204:207]
  v_mfma_f32_16x16x32_bf16 v[200:203], v[40:43], v[156:159], v[200:203]
  v_mfma_f32_16x16x32_bf16 v[212:215], v[44:47], v[156:159], v[212:215]
  v_mfma_f32_16x16x32_bf16 v[208:211], v[28:31], v[152:155], v[208:211]
  ds_write_b128 v15, v[196:199] offset:0
  v_mfma_f32_16x16x32_bf16 v[220:223], v[32:35], v[152:155], v[220:223]
  ds_write_b128 v15, v[192:195] offset:1024
  v_mfma_f32_16x16x32_bf16 v[216:219], v[36:39], v[152:155], v[216:219]
  ds_write_b128 v15, v[204:207] offset:2048
  v_mfma_f32_16x16x32_bf16 v[228:231], v[40:43], v[152:155], v[228:231]
  ds_write_b128 v15, v[200:203] offset:3072
  v_mfma_f32_16x16x32_bf16 v[224:227], v[44:47], v[152:155], v[224:227]
  ds_write_b128 v15, v[212:215] offset:4096
  v_mfma_f32_16x16x32_bf16 v[236:239], v[28:31], v[164:167], v[236:239]
  ds_write_b128 v15, v[208:211] offset:5120
  v_mfma_f32_16x16x32_bf16 v[232:235], v[32:35], v[164:167], v[232:235]
  ds_write_b128 v15, v[220:223] offset:6144
  v_mfma_f32_16x16x32_bf16 v[48:51], v[36:39], v[164:167], v[48:51]
  ds_write_b128 v15, v[216:219] offset:7168
  v_mfma_f32_16x16x32_bf16 v[52:55], v[40:43], v[164:167], v[52:55]
  ds_write_b128 v15, v[228:231] offset:8192
  v_mfma_f32_16x16x32_bf16 v[56:59], v[44:47], v[164:167], v[56:59]
  ds_write_b128 v15, v[224:227] offset:9216
  v_mfma_f32_16x16x32_bf16 v[60:63], v[28:31], v[160:163], v[60:63]
  ds_write_b128 v15, v[236:239] offset:10240
  v_mfma_f32_16x16x32_bf16 v[64:67], v[32:35], v[160:163], v[64:67]
  ds_write_b128 v15, v[232:235] offset:11264
  v_mfma_f32_16x16x32_bf16 v[68:71], v[36:39], v[160:163], v[68:71]
  ds_write_b128 v15, v[48:51] offset:12288
  v_mfma_f32_16x16x32_bf16 v[72:75], v[40:43], v[160:163], v[72:75]
  ds_write_b128 v15, v[52:55] offset:13312
  v_mfma_f32_16x16x32_bf16 v[76:79], v[44:47], v[160:163], v[76:79]
  ds_write_b128 v15, v[56:59] offset:14336
  s_nop 1
  ds_write_b128 v15, v[60:63] offset:15360
  ds_write_b128 v15, v[64:67] offset:16384
  ds_write_b128 v15, v[68:71] offset:17408
  s_nop 0
  ds_write_b128 v15, v[72:75] offset:18432
  s_nop 0
  ds_write_b128 v15, v[76:79] offset:19456
L_28:
  v_add_u32 v15, 61440, v14
  v_add_u32 v1, 122880, v14
  v_lshlrev_b32 v20, 16, v2
  v_and_b32 v21, 0xffff0000, v2
  v_lshlrev_b32 v22, 16, v3
  v_and_b32 v23, 0xffff0000, v3
  v_lshlrev_b32 v24, 16, v4
  v_and_b32 v25, 0xffff0000, v4
  v_lshlrev_b32 v26, 16, v5
  v_and_b32 v27, 0xffff0000, v5
  v_lshlrev_b32 v28, 16, v8
  v_and_b32 v29, 0xffff0000, v8
  v_lshlrev_b32 v30, 16, v9
  v_and_b32 v31, 0xffff0000, v9
  s_waitcnt lgkmcnt(0)
  s_barrier
  ds_read_b128 v[96:99], v14 offset:0
  ds_read_b128 v[100:103], v14 offset:20480
  ds_read_b128 v[104:107], v14 offset:40960
  ds_read_b128 v[108:111], v15 offset:0
  ds_read_b128 v[112:115], v15 offset:20480
  ds_read_b128 v[116:119], v15 offset:40960
  ds_read_b128 v[120:123], v1 offset:0
  ds_read_b128 v[124:127], v1 offset:20480
  ds_read_b128 v[128:131], v14 offset:8192
  ds_read_b128 v[132:135], v14 offset:28672
  ds_read_b128 v[136:139], v14 offset:49152
  ds_read_b128 v[140:143], v15 offset:8192
  ds_read_b128 v[144:147], v15 offset:28672
  ds_read_b128 v[148:151], v15 offset:49152
  ds_read_b128 v[152:155], v1 offset:8192
  ds_read_b128 v[156:159], v1 offset:28672
  s_cmp_ge_u32 s34, 4
  s_cbranch_scc1 L_45
  s_waitcnt lgkmcnt(8)
  ds_read_b128 v[160:163], v14 offset:16384
  ds_read_b128 v[164:167], v14 offset:36864
  ds_read_b128 v[168:171], v14 offset:57344
  ds_read_b128 v[172:175], v15 offset:16384
  ds_read_b128 v[176:179], v15 offset:36864
  ds_read_b128 v[180:183], v15 offset:57344
  ds_read_b128 v[184:187], v1 offset:16384
  ds_read_b128 v[188:191], v1 offset:36864
  v_pk_add_f32 v[96:97], v[96:97], v[112:113]
  v_pk_add_f32 v[98:99], v[98:99], v[114:115]
  v_pk_add_f32 v[100:101], v[100:101], v[116:117]
  v_pk_add_f32 v[102:103], v[102:103], v[118:119]
  v_pk_add_f32 v[104:105], v[104:105], v[120:121]
  v_pk_add_f32 v[106:107], v[106:107], v[122:123]
  v_pk_add_f32 v[108:109], v[108:109], v[124:125]
  v_pk_add_f32 v[110:111], v[110:111], v[126:127]
  v_pk_add_f32 v[96:97], v[96:97], v[104:105]
  v_pk_add_f32 v[98:99], v[98:99], v[106:107]
  v_pk_add_f32 v[100:101], v[100:101], v[108:109]
  v_pk_add_f32 v[102:103], v[102:103], v[110:111]
  v_pk_add_f32 v[96:97], v[96:97], v[100:101]
  v_pk_add_f32 v[98:99], v[98:99], v[102:103]
  v_pk_add_f32 v[96:97], v[96:97], v[20:21]
  v_pk_add_f32 v[98:99], v[98:99], v[22:23]
  v_cvt_pk_bf16_f32 v96, v96, v97
  v_cvt_pk_bf16_f32 v97, v98, v99
  buffer_store_dwordx2 v[96:97], v16, s[24:27], 0 offen
  s_waitcnt lgkmcnt(8)
  v_pk_add_f32 v[128:129], v[128:129], v[144:145]
  v_pk_add_f32 v[130:131], v[130:131], v[146:147]
  v_pk_add_f32 v[132:133], v[132:133], v[148:149]
  v_pk_add_f32 v[134:135], v[134:135], v[150:151]
  v_pk_add_f32 v[136:137], v[136:137], v[152:153]
  v_pk_add_f32 v[138:139], v[138:139], v[154:155]
  v_pk_add_f32 v[140:141], v[140:141], v[156:157]
  v_pk_add_f32 v[142:143], v[142:143], v[158:159]
  v_pk_add_f32 v[128:129], v[128:129], v[136:137]
  v_pk_add_f32 v[130:131], v[130:131], v[138:139]
  v_pk_add_f32 v[132:133], v[132:133], v[140:141]
  v_pk_add_f32 v[134:135], v[134:135], v[142:143]
  v_pk_add_f32 v[128:129], v[128:129], v[132:133]
  v_pk_add_f32 v[130:131], v[130:131], v[134:135]
  v_pk_add_f32 v[128:129], v[128:129], v[24:25]
  v_pk_add_f32 v[130:131], v[130:131], v[26:27]
  v_cvt_pk_bf16_f32 v128, v128, v129
  v_cvt_pk_bf16_f32 v129, v130, v131
  buffer_store_dwordx2 v[128:129], v17, s[24:27], 0 offen
  s_waitcnt lgkmcnt(0)
  v_pk_add_f32 v[160:161], v[160:161], v[176:177]
  v_pk_add_f32 v[162:163], v[162:163], v[178:179]
  v_pk_add_f32 v[164:165], v[164:165], v[180:181]
  v_pk_add_f32 v[166:167], v[166:167], v[182:183]
  v_pk_add_f32 v[168:169], v[168:169], v[184:185]
  v_pk_add_f32 v[170:171], v[170:171], v[186:187]
  v_pk_add_f32 v[172:173], v[172:173], v[188:189]
  v_pk_add_f32 v[174:175], v[174:175], v[190:191]
  v_pk_add_f32 v[160:161], v[160:161], v[168:169]
  v_pk_add_f32 v[162:163], v[162:163], v[170:171]
  v_pk_add_f32 v[164:165], v[164:165], v[172:173]
  v_pk_add_f32 v[166:167], v[166:167], v[174:175]
  v_pk_add_f32 v[160:161], v[160:161], v[164:165]
  v_pk_add_f32 v[162:163], v[162:163], v[166:167]
  v_pk_add_f32 v[160:161], v[160:161], v[28:29]
  v_pk_add_f32 v[162:163], v[162:163], v[30:31]
  v_cvt_pk_bf16_f32 v160, v160, v161
  v_cvt_pk_bf16_f32 v161, v162, v163
  buffer_store_dwordx2 v[160:161], v18, s[24:27], 0 offen
  s_branch L_44
L_45:
  s_waitcnt lgkmcnt(8)
  v_pk_add_f32 v[96:97], v[96:97], v[112:113]
  v_pk_add_f32 v[98:99], v[98:99], v[114:115]
  v_pk_add_f32 v[100:101], v[100:101], v[116:117]
  v_pk_add_f32 v[102:103], v[102:103], v[118:119]
  v_pk_add_f32 v[104:105], v[104:105], v[120:121]
  v_pk_add_f32 v[106:107], v[106:107], v[122:123]
  v_pk_add_f32 v[108:109], v[108:109], v[124:125]
  v_pk_add_f32 v[110:111], v[110:111], v[126:127]
  v_pk_add_f32 v[96:97], v[96:97], v[104:105]
  v_pk_add_f32 v[98:99], v[98:99], v[106:107]
  v_pk_add_f32 v[100:101], v[100:101], v[108:109]
  v_pk_add_f32 v[102:103], v[102:103], v[110:111]
  v_pk_add_f32 v[96:97], v[96:97], v[100:101]
  v_pk_add_f32 v[98:99], v[98:99], v[102:103]
  v_pk_add_f32 v[96:97], v[96:97], v[20:21]
  v_pk_add_f32 v[98:99], v[98:99], v[22:23]
  v_cvt_pk_bf16_f32 v96, v96, v97
  v_cvt_pk_bf16_f32 v97, v98, v99
  buffer_store_dwordx2 v[96:97], v16, s[24:27], 0 offen
  s_waitcnt lgkmcnt(0)
  v_pk_add_f32 v[128:129], v[128:129], v[144:145]
  v_pk_add_f32 v[130:131], v[130:131], v[146:147]
  v_pk_add_f32 v[132:133], v[132:133], v[148:149]
  v_pk_add_f32 v[134:135], v[134:135], v[150:151]
  v_pk_add_f32 v[136:137], v[136:137], v[152:153]
  v_pk_add_f32 v[138:139], v[138:139], v[154:155]
  v_pk_add_f32 v[140:141], v[140:141], v[156:157]
  v_pk_add_f32 v[142:143], v[142:143], v[158:159]
  v_pk_add_f32 v[128:129], v[128:129], v[136:137]
  v_pk_add_f32 v[130:131], v[130:131], v[138:139]
  v_pk_add_f32 v[132:133], v[132:133], v[140:141]
  v_pk_add_f32 v[134:135], v[134:135], v[142:143]
  v_pk_add_f32 v[128:129], v[128:129], v[132:133]
  v_pk_add_f32 v[130:131], v[130:131], v[134:135]
  v_pk_add_f32 v[128:129], v[128:129], v[24:25]
  v_pk_add_f32 v[130:131], v[130:131], v[26:27]
  v_cvt_pk_bf16_f32 v128, v128, v129
  v_cvt_pk_bf16_f32 v129, v130, v131
  buffer_store_dwordx2 v[128:129], v17, s[24:27], 0 offen
L_44:
END:
  s_endpgm
SP_4:
  s_mov_b32 s71, 0
LP_6:
  s_mov_b32 s38, 21037056
  buffer_load_dwordx2 v[80:81], v17, s[20:23], s38 offen sc1
  s_mov_b32 s38, 21078016
  buffer_load_dwordx2 v[82:83], v17, s[20:23], s38 offen sc1
  s_mov_b32 s38, 21118976
  buffer_load_dwordx2 v[84:85], v17, s[20:23], s38 offen sc1
  s_mov_b32 s38, 21159936
  buffer_load_dwordx2 v[86:87], v17, s[20:23], s38 offen sc1
  s_mov_b32 s38, 21200896
  buffer_load_dwordx2 v[88:89], v17, s[20:23], s38 offen sc1
  buffer_load_dwordx4 v[20:23], v18, s[20:23], 0 offen sc1
  s_waitcnt vmcnt(0)
  v_xor_b32 v81, s3, v81
  v_xor_b32 v83, s3, v83
  v_xor_b32 v85, s3, v85
  v_xor_b32 v87, s3, v87
  v_xor_b32 v89, s3, v89
  v_xor_b32 v22, s3, v22
  v_or_b32 v81, v81, v22
  v_or3_b32 v81, v81, v83, v85
  v_or3_b32 v81, v81, v87, v89
  v_cmp_ne_u32 vcc, 0, v81
  s_cbranch_vccz RT_5
  s_add_u32 s71, s71, 1
  s_cmp_lt_u32 s71, 0x40000
  s_cbranch_scc1 LP_6
  s_branch RT_5
SP_7:
  s_mov_b32 s71, 0
LP_9:
  buffer_load_dwordx4 v[20:23], v18, s[20:23], 0 offen sc1
  s_waitcnt vmcnt(0)
  v_cmp_ne_u32 vcc, s3, v22
  s_cbranch_vccz RT_8
  s_add_u32 s71, s71, 1
  s_cmp_lt_u32 s71, 0x40000
  s_cbranch_scc1 LP_9
  s_branch RT_8
SP_10:
  s_mov_b32 s71, 0
LP_12:
  s_mov_b32 s38, 21037056
  buffer_load_dwordx2 v[80:81], v17, s[20:23], s38 offen sc1
  s_mov_b32 s38, 21078016
  buffer_load_dwordx2 v[82:83], v17, s[20:23], s38 offen sc1
  s_mov_b32 s38, 21118976
  buffer_load_dwordx2 v[84:85], v17, s[20:23], s38 offen sc1
  s_mov_b32 s38, 21159936
  buffer_load_dwordx2 v[86:87], v17, s[20:23], s38 offen sc1
  s_mov_b32 s38, 21200896
  buffer_load_dwordx2 v[88:89], v17, s[20:23], s38 offen sc1
  buffer_load_dwordx4 v[20:23], v18, s[20:23], 0 offen sc1
  s_waitcnt vmcnt(0)
  v_xor_b32 v81, s3, v81
  v_xor_b32 v83, s3, v83
  v_xor_b32 v85, s3, v85
  v_xor_b32 v87, s3, v87
  v_xor_b32 v89, s3, v89
  v_xor_b32 v22, s3, v22
  v_or_b32 v81, v81, v22
  v_or3_b32 v81, v81, v83, v85
  v_or3_b32 v81, v81, v87, v89
  v_cmp_ne_u32 vcc, 0, v81
  s_cbranch_vccz RT_11
  s_add_u32 s71, s71, 1
  s_cmp_lt_u32 s71, 0x40000
  s_cbranch_scc1 LP_12
  s_branch RT_11
SP_13:
  s_mov_b32 s71, 0
LP_15:
  buffer_load_dword v184, v185, s[20:23], 0 offen sc1
  s_waitcnt vmcnt(0)
  v_subrev_u32 v184, s3, v184
  v_subrev_u32 v184, 1, v184
  v_cmp_lt_u32 vcc, 2, v184
  s_cbranch_vccz RT_14
  s_add_u32 s71, s71, 1
  s_cmp_lt_u32 s71, 0x40000
  s_cbranch_scc1 LP_15
  s_branch RT_14
SP_16:
  s_mov_b32 s71, 0
LP_18:
  s_mov_b32 s38, 21038080
  buffer_load_dwordx2 v[96:97], v17, s[20:23], s38 offen sc1
  s_mov_b32 s38, 21079040
  buffer_load_dwordx2 v[98:99], v17, s[20:23], s38 offen sc1
  s_mov_b32 s38, 21120000
  buffer_load_dwordx2 v[100:101], v17, s[20:23], s38 offen sc1
  s_mov_b32 s38, 21160960
  buffer_load_dwordx2 v[102:103], v17, s[20:23], s38 offen sc1
  s_mov_b32 s38, 21201920
  buffer_load_dwordx2 v[104:105], v17, s[20:23], s38 offen sc1
  s_waitcnt vmcnt(0)
  v_xor_b32 v97, s3, v97
  v_xor_b32 v99, s3, v99
  v_xor_b32 v101, s3, v101
  v_xor_b32 v103, s3, v103
  v_xor_b32 v105, s3, v105
  v_or3_b32 v97, v97, v99, v101
  v_or3_b32 v97, v97, v103, v105
  v_cmp_ne_u32 vcc, 0, v97
  s_cbranch_vccz RT_17
  s_add_u32 s71, s71, 1
  s_cmp_lt_u32 s71, 0x40000
  s_cbranch_scc1 LP_18
  s_branch RT_17
LT_20:
  v_subrev_u32 v13, 117440512, v13
  s_mov_b32 s71, 0
LP_22:
  buffer_load_dword v19, v7, s[20:23], 0 offen sc1
  s_waitcnt vmcnt(0)
  v_subrev_u32 v19, s3, v19
  v_subrev_u32 v19, 2, v19
  v_cmp_lt_u32 vcc, 1, v19
  s_cbranch_vccz GO_23
  s_add_u32 s71, s71, 1
  s_cmp_lt_u32 s71, 0x40000
  s_cbranch_scc1 LP_22
GO_23:
  s_mov_b32 s39, 7864320
  buffer_load_dwordx4 v[140:143], v13, s[20:23], s39 offen sc1
  s_mov_b32 s39, 7933952
  buffer_load_dwordx4 v[136:139], v13, s[20:23], s39 offen sc1
  s_mov_b32 s39, 8003584
  buffer_load_dwordx4 v[148:151], v13, s[20:23], s39 offen sc1
  s_mov_b32 s39, 8073216
  buffer_load_dwordx4 v[144:147], v13, s[20:23], s39 offen sc1
  s_mov_b32 s39, 7872512
  buffer_load_dwordx4 v[156:159], v13, s[20:23], s39 offen sc1
  s_mov_b32 s39, 7942144
  buffer_load_dwordx4 v[152:155], v13, s[20:23], s39 offen sc1
  s_mov_b32 s39, 8011776
  buffer_load_dwordx4 v[164:167], v13, s[20:23], s39 offen sc1
  s_mov_b32 s39, 8081408
  buffer_load_dwordx4 v[160:163], v13, s[20:23], s39 offen sc1
  s_mov_b32 s39, 7880704
  buffer_load_dwordx4 v[172:175], v13, s[20:23], s39 offen sc1
  s_mov_b32 s39, 7950336
  buffer_load_dwordx4 v[168:171], v13, s[20:23], s39 offen sc1
  s_mov_b32 s39, 8019968
  buffer_load_dwordx4 v[180:183], v13, s[20:23], s39 offen sc1
  s_mov_b32 s39, 8089600
  buffer_load_dwordx4 v[176:179], v13, s[20:23], s39 offen sc1
  s_waitcnt vmcnt(0)
  s_branch RT_21
SP_29:
  s_mov_b32 s71, 0
LP_31:
  s_mov_b32 s39, 7913472
  buffer_load_dwordx4 v[140:143], v13, s[20:23], s39 offen sc1
  s_mov_b32 s39, 7983104
  buffer_load_dwordx4 v[136:139], v13, s[20:23], s39 offen sc1
  s_mov_b32 s39, 8052736
  buffer_load_dwordx4 v[148:151], v13, s[20:23], s39 offen sc1
  s_mov_b32 s39, 8122368
  buffer_load_dwordx4 v[144:147], v13, s[20:23], s39 offen sc1
  s_mov_b32 s39, 7921664
  buffer_load_dwordx4 v[156:159], v13, s[20:23], s39 offen sc1
  s_mov_b32 s39, 7991296
  buffer_load_dwordx4 v[152:155], v13, s[20:23], s39 offen sc1
  s_mov_b32 s39, 8060928
  buffer_load_dwordx4 v[164:167], v13, s[20:23], s39 offen sc1
  s_mov_b32 s39, 8130560
  buffer_load_dwordx4 v[160:163], v13, s[20:23], s39 offen sc1
  s_mov_b32 s39, 7929856
  buffer_load_dwordx4 v[172:175], v13, s[20:23], s39 offen sc1
  s_mov_b32 s39, 7999488
  buffer_load_dwordx4 v[168:171], v13, s[20:23], s39 offen sc1
  s_mov_b32 s39, 8069120
  buffer_load_dwordx4 v[180:183], v13, s[20:23], s39 offen sc1
  s_mov_b32 s39, 8138752
  buffer_load_dwordx4 v[176:179], v13, s[20:23], s39 offen sc1
  s_waitcnt vmcnt(0)
  v_max3_u32 v19, v140, v141, v142
  v_max3_u32 v19, v143, v136, v19
  v_max3_u32 v19, v137, v138, v19
  v_max3_u32 v19, v139, v148, v19
  v_max3_u32 v19, v149, v150, v19
  v_max3_u32 v19, v151, v144, v19
  v_max3_u32 v19, v145, v146, v19
  v_max_u32 v19, v147, v19
  v_cmp_eq_u32 vcc, -1, v19
  s_cbranch_vccz RT_30
  s_add_u32 s71, s71, 1
  s_cmp_lt_u32 s71, 0x40000
  s_cbranch_scc1 LP_31
  s_branch RT_30
SP_32:
  s_mov_b32 s71, 0
LP_34:
  s_mov_b32 s39, 7921664
  buffer_load_dwordx4 v[156:159], v13, s[20:23], s39 offen sc1
  s_mov_b32 s39, 7991296
  buffer_load_dwordx4 v[152:155], v13, s[20:23], s39 offen sc1
  s_mov_b32 s39, 8060928
  buffer_load_dwordx4 v[164:167], v13, s[20:23], s39 offen sc1
  s_mov_b32 s39, 8130560
  buffer_load_dwordx4 v[160:163], v13, s[20:23], s39 offen sc1
  s_mov_b32 s39, 7929856
  buffer_load_dwordx4 v[172:175], v13, s[20:23], s39 offen sc1
  s_mov_b32 s39, 7999488
  buffer_load_dwordx4 v[168:171], v13, s[20:23], s39 offen sc1
  s_mov_b32 s39, 8069120
  buffer_load_dwordx4 v[180:183], v13, s[20:23], s39 offen sc1
  s_mov_b32 s39, 8138752
  buffer_load_dwordx4 v[176:179], v13, s[20:23], s39 offen sc1
  s_waitcnt vmcnt(0)
  v_max3_u32 v19, v156, v157, v158
  v_max3_u32 v19, v159, v152, v19
  v_max3_u32 v19, v153, v154, v19
  v_max3_u32 v19, v155, v164, v19
  v_max3_u32 v19, v165, v166, v19
  v_max3_u32 v19, v167, v160, v19
  v_max3_u32 v19, v161, v162, v19
  v_max_u32 v19, v163, v19
  v_cmp_eq_u32 vcc, -1, v19
  s_cbranch_vccz RT_33
  s_add_u32 s71, s71, 1
  s_cmp_lt_u32 s71, 0x40000
  s_cbranch_scc1 LP_34
  s_branch RT_33
SP_35:
  s_mov_b32 s71, 0
LP_37:
  s_mov_b32 s39, 7929856
  buffer_load_dwordx4 v[172:175], v13, s[20:23], s39 offen sc1
  s_mov_b32 s39, 7999488
  buffer_load_dwordx4 v[168:171], v13, s[20:23], s39 offen sc1
  s_mov_b32 s39, 8069120
  buffer_load_dwordx4 v[180:183], v13, s[20:23], s39 offen sc1
  s_mov_b32 s39, 8138752
  buffer_load_dwordx4 v[176:179], v13, s[20:23], s39 offen sc1
  s_waitcnt vmcnt(0)
  v_max3_u32 v19, v172, v173, v174
  v_max3_u32 v19, v175, v168, v19
  v_max3_u32 v19, v169, v170, v19
  v_max3_u32 v19, v171, v180, v19
  v_max3_u32 v19, v181, v182, v19
  v_max3_u32 v19, v183, v176, v19
  v_max3_u32 v19, v177, v178, v19
  v_max_u32 v19, v179, v19
  v_cmp_eq_u32 vcc, -1, v19
  s_cbranch_vccz RT_36
  s_add_u32 s71, s71, 1
  s_cmp_lt_u32 s71, 0x40000
  s_cbranch_scc1 LP_37
  s_branch RT_36
SP_38:
  s_mov_b32 s71, 0
LP_40:
  s_mov_b32 s39, 7913472
  buffer_load_dwordx4 v[140:143], v13, s[20:23], s39 offen sc1
  s_mov_b32 s39, 7983104
  buffer_load_dwordx4 v[136:139], v13, s[20:23], s39 offen sc1
  s_mov_b32 s39, 8052736
  buffer_load_dwordx4 v[148:151], v13, s[20:23], s39 offen sc1
  s_mov_b32 s39, 8122368
  buffer_load_dwordx4 v[144:147], v13, s[20:23], s39 offen sc1
  s_mov_b32 s39, 7921664
  buffer_load_dwordx4 v[156:159], v13, s[20:23], s39 offen sc1
  s_mov_b32 s39, 7991296
  buffer_load_dwordx4 v[152:155], v13, s[20:23], s39 offen sc1
  s_mov_b32 s39, 8060928
  buffer_load_dwordx4 v[164:167], v13, s[20:23], s39 offen sc1
  s_mov_b32 s39, 8130560
  buffer_load_dwordx4 v[160:163], v13, s[20:23], s39 offen sc1
  s_waitcnt vmcnt(0)
  v_max3_u32 v19, v140, v141, v142
  v_max3_u32 v19, v143, v136, v19
  v_max3_u32 v19, v137, v138, v19
  v_max3_u32 v19, v139, v148, v19
  v_max3_u32 v19, v149, v150, v19
  v_max3_u32 v19, v151, v144, v19
  v_max3_u32 v19, v145, v146, v19
  v_max_u32 v19, v147, v19
  v_cmp_eq_u32 vcc, -1, v19
  s_cbranch_vccz RT_39
  s_add_u32 s71, s71, 1
  s_cmp_lt_u32 s71, 0x40000
  s_cbranch_scc1 LP_40
  s_branch RT_39
SP_41:
  s_mov_b32 s71, 0
LP_43:
  s_mov_b32 s39, 7921664
  buffer_load_dwordx4 v[156:159], v13, s[20:23], s39 offen sc1
  s_mov_b32 s39, 7991296
  buffer_load_dwordx4 v[152:155], v13, s[20:23], s39 offen sc1
  s_mov_b32 s39, 8060928
  buffer_load_dwordx4 v[164:167], v13, s[20:23], s39 offen sc1
  s_mov_b32 s39, 8130560
  buffer_load_dwordx4 v[160:163], v13, s[20:23], s39 offen sc1
  s_waitcnt vmcnt(0)
  v_max3_u32 v19, v156, v157, v158
  v_max3_u32 v19, v159, v152, v19
  v_max3_u32 v19, v153, v154, v19
  v_max3_u32 v19, v155, v164, v19
  v_max3_u32 v19, v165, v166, v19
  v_max3_u32 v19, v167, v160, v19
  v_max3_u32 v19, v161, v162, v19
  v_max_u32 v19, v163, v19
  v_cmp_eq_u32 vcc, -1, v19
  s_cbranch_vccz RT_42
  s_add_u32 s71, s71, 1
  s_cmp_lt_u32 s71, 0x40000
  s_cbranch_scc1 LP_43
  s_branch RT_42
.section .rodata,"a"
.p2align 6
.amdhsa_kernel parallel_sum__sliding_block__glu_gated_bilinear__prompt_kernel
  .amdhsa_next_free_vgpr 256
  .amdhsa_next_free_sgpr 96
  .amdhsa_accum_offset 256
  .amdhsa_group_segment_fixed_size 0
  .amdhsa_kernarg_size 80
  .amdhsa_user_sgpr_count 2
  .amdhsa_user_sgpr_kernarg_segment_ptr 1
  .amdhsa_system_sgpr_workgroup_id_x 1
.end_amdhsa_kernel
```
